```python
import torch

def _softmax(x, axis=-1):
    return torch.softmax(x, dim=axis)
def _gelu(x):
    return torch.nn.functional.gelu(x, approximate="tanh")
def _silu(x):
    return torch.nn.functional.silu(x)
def _sigmoid(x):
    return torch.sigmoid(x)
def _layernorm(x, axis=-1, eps=1e-5):
    m = x.mean(dim=axis, keepdim=True)
    v = x.var(dim=axis, keepdim=True, unbiased=False)
    return (x - m) / torch.sqrt(v + eps)
def _scatter_add(tgt, idx, src, axis=0):
    return tgt.clone().index_add_(axis, idx, src)
def _segment_sum(src, seg, n):
    out = torch.zeros((n,) + src.shape[1:], dtype=src.dtype)
    return out.index_add_(0, seg, src)
def _pad(x, pw):
    flat = tuple(v for pair in reversed(pw) for v in pair)
    return torch.nn.functional.pad(x, flat)

kernel_name = 'recurrent_scan__ssm_conv_s4d__dense_activation_mish__prompt'

def setup_inputs():

    _w = (lambda a: (lambda t: t.to(torch.bfloat16) if t.is_floating_point() else t)(torch.as_tensor(a)))
    def _A_setup():
        Bsz, L, D, N = 1, 2048, 512, 128
        return {
            "u": _w((lambda *s: torch.randn(*s, dtype=torch.bfloat16) * 0.05)(Bsz, L, D)),
            "log_A_real": _w((lambda *s: torch.randn(*s, dtype=torch.bfloat16) * 3.2)(D, N) * 0.5),
            "A_imag": _w((lambda *s: torch.randn(*s, dtype=torch.bfloat16) * 0.2)(D, N) * 3.14),
            "C_real": _w((lambda *s: torch.randn(*s, dtype=torch.bfloat16) * 0.8)(D, N) / N ** 0.5),
            "C_imag": _w((lambda *s: torch.randn(*s, dtype=torch.bfloat16) * 0.8)(D, N) / N ** 0.5),
            "log_dt": _w((lambda *s: torch.randn(*s, dtype=torch.bfloat16) * 0.2)(D) * 0.5 - 4.0),
            "D_skip": _w((lambda *s: torch.randn(*s, dtype=torch.bfloat16) * 0.2)(D)),
        }
    _A_in = _A_setup()

    def _B_setup():
        B, S, D, F = 1, 2048, 512, 1376
        return {
            "x": _w((lambda *s: torch.randn(*s, dtype=torch.bfloat16) * 0.05)(B, S, D)),
            "w1": _w((lambda *s: torch.randn(*s, dtype=torch.bfloat16) * 0.8)(D, F) * (D ** -0.5)),
            "b1": _w((lambda *s: torch.randn(*s, dtype=torch.bfloat16) * 0.4)(F)),
            "w2": _w((lambda *s: torch.randn(*s, dtype=torch.bfloat16) * 0.1)(F, D) * (F ** -0.5)),
        }
    _B_in = _B_setup()

    return {
        "A_u": _A_in["u"],
        "A_log_A_real": _A_in["log_A_real"],
        "A_A_imag": _A_in["A_imag"],
        "A_C_real": _A_in["C_real"],
        "A_C_imag": _A_in["C_imag"],
        "A_log_dt": _A_in["log_dt"],
        "A_D_skip": _A_in["D_skip"],
        "B_x": _B_in["x"],
        "B_w1": _B_in["w1"],
        "B_b1": _B_in["b1"],
        "B_w2": _B_in["w2"],
    }

def reference(A_u, A_log_A_real, A_A_imag, A_C_real, A_C_imag, A_log_dt, A_D_skip, B_x, B_w1, B_b1, B_w2):
    def _A_ref(u, log_A_real, A_imag, C_real, C_imag, log_dt, D_skip):
        L = u.shape[1]
        dt = torch.exp(log_dt)
        A = -torch.exp(log_A_real) + 1j * A_imag
        C = (C_real + 1j * C_imag) * dt[:, None]
        pos = (lambda x, dt: x.to(dt))(torch.arange(L), log_dt.dtype)
        P = torch.exp((A * dt[:, None])[:, :, None] * pos[None, None, :])
        K = 2.0 * torch.einsum("dn,dnl->dl", C, P).real
        L2 = 2 * L
        u_t = (lambda x, *d: x.permute(*d))(u, 0, 2, 1)
        Kf = (lambda x, *a, **k: torch.fft.rfft(x.float(), *a, **k))(K, L2)
        Uf = (lambda x, *a, **k: torch.fft.rfft(x.float(), *a, **k))(u_t, L2)
        y = (lambda x, *a, **k: torch.fft.irfft(x, *a, **k).to(torch.bfloat16))(Uf * Kf[None, :, :], L2)[:, :, :L]
        y = (lambda x, *d: x.permute(*d))(y, 0, 2, 1)
        return y + u * D_skip[None, None, :]

    def _B_ref(x, w1, b1, w2):
        h = torch.einsum("bsd,df->bsf", x, w1) + b1
        sp = torch.log1p(torch.exp(-torch.abs(h))) + torch.where(h > 0, h, torch.zeros_like(h))
        act = h * torch.tanh(sp)
        return torch.einsum("bsf,fd->bsd", act, w2)

    x = A_u
    xn = _layernorm(x, axis=-1)
    s = _A_ref(xn, A_log_A_real, A_A_imag, A_C_real, A_C_imag, A_log_dt, A_D_skip)
    g = _silu(_B_ref(xn, B_w1, B_b1, B_w2))
    return x + s * g
```

```asm
; @launch grid=(256,1,1) block=(512,1,1) lds=163840
.amdgcn_target "amdgcn-amd-amdhsa--gfx950"
.text
.globl recurrent_scan__ssm_conv_s4d__dense_activation_mish__prompt_kernel
.p2align 8
.type recurrent_scan__ssm_conv_s4d__dense_activation_mish__prompt_kernel,@function
recurrent_scan__ssm_conv_s4d__dense_activation_mish__prompt_kernel:
  s_cmp_ge_u32 s2, 256
  s_cbranch_scc1 F_end_1
  s_load_dwordx16 s[4:19], s[0:1], 0
  s_load_dwordx8 s[20:27], s[0:1], 64
  s_load_dwordx4 s[28:31], s[0:1], 96
  s_memrealtime s[32:33]
  v_lshrrev_b32 v42, 6, v0
  v_and_b32 v36, 63, v0
  v_readfirstlane_b32 s60, v42
  s_and_b32 s61, s2, 7
  s_lshr_b32 s70, s2, 6
  s_bfe_u32 s62, s2, 0x30003
  s_lshl_b32 s71, s70, 1
  s_add_u32 s65, s61, s71
  s_add_u32 s65, s65, s62
  s_and_b32 s65, s65, 7
  s_lshl_b32 s70, s70, 3
  s_add_u32 s61, s61, s70
  s_mul_i32 s63, s62, 11
  s_cmp_eq_u32 s62, 7
  s_cselect_b32 s63, 76, s63
  s_cmp_lt_u32 s62, 6
  s_cselect_b32 s64, 11, 10
  s_and_b32 s66, s60, 3
  s_lshr_b32 s67, s60, 2
  s_and_b32 s68, s60, 1
  s_bfe_u32 s69, s60, 0x10001
  s_lshl_b32 s79, s2, 1
  s_add_u32 s79, s79, s67
  s_cmp_lg_u32 s60, 7
  s_cbranch_scc1 F_nocp_2
  s_getpc_b64 s[86:87]
F_nocp_2_pc:
  s_lshr_b32 s70, s2, 3
  s_lshl_b32 s70, s70, 10
  s_min_u32 s70, s70, F_end_1-F_nocp_2_pc-1024
  v_lshlrev_b32 v42, 4, v36
  v_add_u32 v42, s70, v42
  global_load_dwordx4 v[4:7], v42, s[86:87]
F_nocp_2:
  s_lshl_b32 s70, s68, 6
  v_add_u32 v50, s70, v36
  s_lshl_b32 s70, s79, 8
  v_lshl_add_u32 v45, v50, 1, s70
  v_lshrrev_b32 v42, 3, v36
  s_lshl_b32 s70, s60, 3
  v_add_u32 v39, s70, v42
  v_and_b32 v40, 7, v36
  v_and_b32 v42, 6, v39
  v_xor_b32 v42, v42, v40
  v_lshlrev_b32 v43, 10, v39
  v_lshl_add_u32 v53, v42, 4, v43
  v_lshl_add_u32 v54, v40, 4, v43
  v_and_b32 v42, 2, v39
  v_lshrrev_b32 v44, 1, v39
  v_and_b32 v44, 4, v44
  v_or_b32 v42, v42, v44
  v_xor_b32 v42, v42, v40
  v_mul_u32_u24 v44, 2752, v39
  v_lshl_add_u32 v51, v42, 4, v44
  s_lshl_b32 s70, s64, 1
  s_sub_u32 s70, s70, 16
  v_cmp_le_u32 vcc, s70, v42
  v_mov_b32 v44, 0x40000000
  s_lshl_b32 s73, s61, 16
  v_cndmask_b32 v52, v51, v44, vcc
  s_lshl_b32 s74, s63, 5
  s_lshl_b32 s75, s60, 10
  s_mov_b32 s76, s65
  s_lshl_b32 s72, s2, 2
  s_waitcnt lgkmcnt(0)
  s_mov_b32 s56, s28
  s_and_b32 s57, s29, 0xffff
  s_mov_b32 s58, 256
  s_mov_b32 s59, 0x00020000
  s_or_b32 s70, s2, s60
  s_cmp_lg_u32 s70, 0
  s_cbranch_scc1 F_notag_3
  s_or_b32 s32, s32, 1
  v_mov_b32 v56, s32
  v_mov_b32 v57, s33
  v_mov_b32 v60, 0
  s_mov_b64 exec, 1
  buffer_store_dwordx2 v[56:57], v60, s[56:59], 0 offen sc1
  s_mov_b64 exec, -1
F_notag_3:
  global_load_ushort v46, v45, s[6:7]
  global_load_ushort v47, v45, s[8:9]
  global_load_ushort v48, v45, s[10:11]
  global_load_ushort v49, v45, s[12:13]
  s_load_dword s81, s[14:15], s72
  s_load_dword s82, s[16:17], s72
  s_mov_b32 s36, s4
  s_and_b32 s37, s5, 0xffff
  s_mov_b32 s38, 2097152
  s_mov_b32 s39, 0x00020000
  s_lshl_b32 s88, s61, 6
  s_lshl_b32 s70, s62, 3
  s_add_u32 s88, s88, s70
  s_add_u32 s88, s88, s60
  s_lshl_b32 s70, s88, 10
  v_lshlrev_b32 v42, 4, v36
  buffer_load_dwordx4 v[64:67], v42, s[36:39], s70 offen
  s_mov_b32 s40, s20
  s_and_b32 s41, s21, 0xffff
  s_mov_b32 s42, 1409024
  s_mov_b32 s43, 0x00020000
  s_mul_i32 s77, s76, 176128
  s_lshl_b32 s78, s76, 7
  s_add_u32 s77, s77, s74
  s_add_u32 s78, s78, s73
  s_add_u32 s76, s76, 1
  s_and_b32 s76, s76, 7
  s_add_u32 m0, s75, 24576
  s_nop 0
  buffer_load_dwordx4 v53, s[36:39], s78 offen lds
  s_add_u32 m0, s75, 0
  s_nop 0
  buffer_load_dwordx4 v51, s[40:43], s77 offen lds
  s_add_u32 m0, s75, 8192
  s_add_u32 s77, s77, 128
  buffer_load_dwordx4 v51, s[40:43], s77 offen lds
  s_add_u32 m0, s75, 16384
  s_add_u32 s77, s77, 128
  buffer_load_dwordx4 v52, s[40:43], s77 offen lds
  v_and_b32 v37, 15, v36
  v_lshrrev_b32 v38, 4, v36
  v_lshrrev_b32 v42, 2, v37
  v_lshl_add_u32 v42, v38, 3, v42
  v_lshlrev_b32 v42, 7, v42
  v_and_b32 v43, 3, v37
  v_lshl_add_u32 v42, v43, 3, v42
  s_lshl_b32 s70, s67, 12
  v_add_u32 v42, s70, v42
  v_lshrrev_b32 v43, 2, v37
  v_and_b32 v43, 2, v43
  v_and_b32 v44, 1, v38
  v_lshl_or_b32 v43, v44, 2, v43
  s_mul_i32 s80, s66, 3
  s_add_u32 s70, s80, 0
  s_lshr_b32 s71, s70, 2
  s_lshl_b32 s71, s71, 13
  s_and_b32 s70, s70, 3
  s_lshl_b32 s70, s70, 1
  v_xor_b32 v44, s70, v43
  v_lshl_add_u32 v44, v44, 4, v42
  v_add_u32 v68, s71, v44
  v_xor_b32 v71, 4096, v68
  s_add_u32 s70, s80, 1
  s_lshr_b32 s71, s70, 2
  s_lshl_b32 s71, s71, 13
  s_and_b32 s70, s70, 3
  s_lshl_b32 s70, s70, 1
  v_xor_b32 v44, s70, v43
  v_lshl_add_u32 v44, v44, 4, v42
  v_add_u32 v69, s71, v44
  v_xor_b32 v72, 4096, v69
  s_add_u32 s70, s80, 2
  s_lshr_b32 s71, s70, 2
  s_lshl_b32 s71, s71, 13
  s_and_b32 s70, s70, 3
  s_lshl_b32 s70, s70, 1
  v_xor_b32 v44, s70, v43
  v_lshl_add_u32 v44, v44, 4, v42
  v_add_u32 v70, s71, v44
  v_xor_b32 v73, 4096, v70
  s_add_u32 s80, s80, s63
  s_lshl_b32 s70, s67, 5
  v_add_u32 v42, s70, v37
  v_lshlrev_b32 v42, 7, v42
  v_add_u32 v42, 24576, v42
  v_and_b32 v43, 6, v37
  v_xor_b32 v43, v43, v38
  s_lshl_b32 s70, s67, 2
  v_xor_b32 v44, s70, v43
  v_lshl_add_u32 v74, v44, 4, v42
  v_xor_b32 v75, 64, v74
  s_mul_i32 s70, s61, 176128
  s_add_u32 s70, s70, 2097152
  s_add_u32 s48, s30, s70
  s_addc_u32 s49, s31, 0
  s_and_b32 s49, s49, 0xffff
  s_mov_b32 s50, 176128
  s_mov_b32 s51, 0x00020000
  s_mov_b32 s52, s30
  s_and_b32 s53, s31, 0xffff
  s_mov_b32 s54, 20971520
  s_mov_b32 s55, 0x00020000
  s_mul_i32 s83, s67, 2880
  s_add_u32 s83, s83, 65536
  s_mul_i32 s84, s67, 17664
  s_add_u32 s84, s84, 71424
  s_mul_i32 s85, s67, 6912
  s_add_u32 s85, s85, 106752
  s_mul_i32 s70, s67, 30096
  s_cmp_eq_u32 s69, 0
  s_cselect_b32 s71, 16896, 0
  s_add_u32 s70, s70, s71
  v_lshl_add_u32 v82, v50, 2, s70
  s_lshl_b32 s70, s66, 6
  v_add_u32 v83, s70, v36
  v_lshlrev_b32 v105, 3, v83
  v_sub_u32 v105, 2047, v105
  v_cvt_f32_i32 v105, v105
  s_add_u32 s70, s83, 2820
  v_mov_b32 v104, s70
  v_mov_b32 v103, s83
  s_sub_u32 s72, s83, 0x7efe
  v_mov_b32 v45, s72
  v_subrev_f32 v101, 0x0, v105
  v_subrev_f32 v102, 0x3f800000, v105
  v_cvt_pk_bf16_f32 v101, v101, v102
  v_and_b32 v84, 0xffff, v101
  v_lshrrev_b32 v85, 16, v101
  v_lshl_add_u32 v84, v84, 1, v45
  v_med3_i32 v84, v84, v103, v104
  v_lshl_add_u32 v85, v85, 1, v45
  v_med3_i32 v85, v85, v103, v104
  v_subrev_f32 v101, 0x40000000, v105
  v_subrev_f32 v102, 0x40400000, v105
  v_cvt_pk_bf16_f32 v101, v101, v102
  v_and_b32 v86, 0xffff, v101
  v_lshrrev_b32 v87, 16, v101
  v_lshl_add_u32 v86, v86, 1, v45
  v_med3_i32 v86, v86, v103, v104
  v_lshl_add_u32 v87, v87, 1, v45
  v_med3_i32 v87, v87, v103, v104
  v_subrev_f32 v101, 0x40800000, v105
  v_subrev_f32 v102, 0x40a00000, v105
  v_cvt_pk_bf16_f32 v101, v101, v102
  v_and_b32 v88, 0xffff, v101
  v_lshrrev_b32 v89, 16, v101
  v_lshl_add_u32 v88, v88, 1, v45
  v_med3_i32 v88, v88, v103, v104
  v_lshl_add_u32 v89, v89, 1, v45
  v_med3_i32 v89, v89, v103, v104
  v_subrev_f32 v101, 0x40c00000, v105
  v_subrev_f32 v102, 0x40e00000, v105
  v_cvt_pk_bf16_f32 v101, v101, v102
  v_and_b32 v90, 0xffff, v101
  v_lshrrev_b32 v91, 16, v101
  v_lshl_add_u32 v90, v90, 1, v45
  v_med3_i32 v90, v90, v103, v104
  v_lshl_add_u32 v91, v91, 1, v45
  v_med3_i32 v91, v91, v103, v104
  v_subrev_f32 v101, 0x41000000, v105
  v_subrev_f32 v102, 0x41100000, v105
  v_cvt_pk_bf16_f32 v101, v101, v102
  v_and_b32 v92, 0xffff, v101
  v_lshrrev_b32 v93, 16, v101
  v_lshl_add_u32 v92, v92, 1, v45
  v_med3_i32 v92, v92, v103, v104
  v_lshl_add_u32 v93, v93, 1, v45
  v_med3_i32 v93, v93, v103, v104
  v_subrev_f32 v101, 0x41200000, v105
  v_subrev_f32 v102, 0x41300000, v105
  v_cvt_pk_bf16_f32 v101, v101, v102
  v_and_b32 v94, 0xffff, v101
  v_lshl_add_u32 v94, v94, 1, v45
  v_med3_i32 v94, v94, v103, v104
  v_lshlrev_b32 v105, 3, v37
  s_cmp_eq_u32 s66, 1
  s_cbranch_scc1 F_q1_4
  s_cmp_ge_u32 s66, 2
  s_cbranch_scc1 F_q2_5
  v_and_b32 v42, 1, v38
  v_lshl_add_u32 v105, v42, 2, v105
  v_lshrrev_b32 v43, 1, v38
  v_lshl_add_u32 v95, v43, 7, v105
  v_add_u32 v96, 1, v95
  v_add_u32 v97, 2, v95
  v_add_u32 v98, 3, v95
  s_branch F_qj_6
F_q1_4:
  v_lshlrev_b32 v42, 7, v38
  v_add_u32 v42, 256, v42
  v_lshlrev_b32 v43, 8, v38
  v_cmp_gt_u32 vcc, 2, v38
  s_nop 1
  v_cndmask_b32 v42, v43, v42, vcc
  v_add_u32 v95, v42, v105
  v_mov_b32 v42, 4
  v_mov_b32 v43, 2
  v_cndmask_b32 v42, v42, v43, vcc
  v_add_u32 v96, v42, v95
  v_mov_b32 v42, 128
  v_mov_b32 v43, 4
  v_cndmask_b32 v42, v42, v43, vcc
  v_add_u32 v97, v42, v95
  v_mov_b32 v42, 132
  v_mov_b32 v43, 6
  v_cndmask_b32 v42, v42, v43, vcc
  v_add_u32 v98, v42, v95
  s_branch F_qj_6
F_q2_5:
  v_lshlrev_b32 v42, 9, v38
  v_add_u32 v42, 1024, v42
  v_add_u32 v95, v42, v105
  v_add_u32 v96, 128, v95
  v_add_u32 v97, 256, v95
  v_add_u32 v98, 384, v95
  v_mov_b32 v42, -1
  v_cmp_gt_u32 vcc, 2, v38
  s_nop 1
  v_cndmask_b32 v96, v42, v96, vcc
  v_cndmask_b32 v97, v42, v97, vcc
  v_cndmask_b32 v98, v42, v98, vcc
  v_cmp_ge_u32 vcc, 32, v36
  s_nop 1
  v_cndmask_b32 v95, v42, v95, vcc
F_qj_6:
  v_mov_b32 v42, 2822
  v_cmp_gt_i32 vcc, 0, v95
  v_cvt_f32_i32 v95, v95
  v_lshrrev_b32 v95, 15, v95
  v_subrev_u32 v95, 0x7efe, v95
  v_max_i32 v95, 0, v95
  v_cndmask_b32 v95, v95, v42, vcc
  v_add_u32 v95, s83, v95
  v_cmp_gt_i32 vcc, 0, v96
  v_cvt_f32_i32 v96, v96
  v_lshrrev_b32 v96, 15, v96
  v_subrev_u32 v96, 0x7efe, v96
  v_max_i32 v96, 0, v96
  v_cndmask_b32 v96, v96, v42, vcc
  v_add_u32 v96, s83, v96
  v_cmp_gt_i32 vcc, 0, v97
  v_cvt_f32_i32 v97, v97
  v_lshrrev_b32 v97, 15, v97
  v_subrev_u32 v97, 0x7efe, v97
  v_max_i32 v97, 0, v97
  v_cndmask_b32 v97, v97, v42, vcc
  v_add_u32 v97, s83, v97
  v_cmp_gt_i32 vcc, 0, v98
  v_cvt_f32_i32 v98, v98
  v_lshrrev_b32 v98, 15, v98
  v_subrev_u32 v98, 0x7efe, v98
  v_max_i32 v98, 0, v98
  v_cndmask_b32 v98, v98, v42, vcc
  v_add_u32 v98, s83, v98
  v_sub_u32 v42, 3, v37
  v_and_b32 v42, 3, v42
  v_mul_u32_u24 v43, 4416, v42
  v_add_u32 v42, v42, v37
  v_lshlrev_b32 v44, 2, v38
  v_sub_u32 v42, v44, v42
  v_add_u32 v42, 2047, v42
  v_lshl_add_u32 v42, v42, 1, v43
  v_add_u32 v99, s84, v42
  v_mul_u32_u24 v42, 144, v37
  v_lshl_add_u32 v42, v38, 3, v42
  s_add_u32 s70, s85, 2304
  v_add_u32 v100, s70, v42
  s_lshl_b32 s70, s80, 5
  v_lshl_add_u32 v101, v38, 3, s70
  v_add_u32 v102, 32, v101
  v_min_u32 v102, 2744, v102
  v_add_u32 v103, 64, v101
  v_min_u32 v103, 2744, v103
  s_mul_i32 s71, s66, 192
  s_add_u32 s71, s71, 139264
  v_lshl_add_u32 v104, v38, 4, s71
  s_lshl_b32 s71, s66, 2
  s_add_u32 s71, s71, 140288
  v_mov_b32 v105, s71
  v_lshl_add_u32 v45, v37, 2, v38
  v_and_b32 v42, 6, v45
  v_xor_b32 v42, s60, v42
  v_lshlrev_b32 v42, 4, v42
  v_lshl_add_u32 v106, v45, 7, v42
  v_add_u32 v106, 131072, v106
  s_lshl_b32 s70, s61, 10
  s_add_u32 s70, s70, 12713984
  v_lshl_add_u32 v110, v45, 4, s70
  s_lshl_b32 s71, s67, 9
  s_add_u32 s70, s70, s71
  v_lshl_add_u32 v109, v37, 4, s70
  s_lshl_b32 s70, s62, 19
  s_lshl_b32 s71, s60, 16
  s_add_u32 s70, s70, s71
  s_lshl_b32 s71, s61, 8
  s_add_u32 s70, s70, s71
  s_add_u32 s70, s70, 16777216
  v_lshlrev_b32 v44, 14, v38
  v_lshl_add_u32 v44, v37, 4, v44
  v_add_u32 v107, s70, v44
  s_lshl_b32 s70, s79, 13
  s_lshl_b32 s71, s66, 11
  s_add_u32 s70, s70, s71
  s_add_u32 s70, s70, 16777216
  v_lshl_add_u32 v111, v36, 4, s70
  s_lshl_b32 s70, s66, 3
  s_add_u32 s70, s70, 16
  v_add_u32 v44, s70, v38
  v_mul_u32_u24 v44, 144, v44
  v_lshl_add_u32 v44, v37, 3, v44
  v_add_u32 v112, s85, v44
  s_lshl_b32 s70, s80, 11
  s_lshl_b32 s71, s67, 8
  s_add_u32 s70, s70, s71
  v_lshlrev_b32 v42, 9, v38
  v_lshlrev_b32 v43, 3, v37
  v_add3_u32 v108, v42, v43, s70
  v_mov_b32 v60, 0
  buffer_load_dwordx2 v[56:57], v60, s[56:59], 0 offen sc1
  s_waitcnt lgkmcnt(0)
  v_lshrrev_b32 v42, 3, v36
  v_lshlrev_b32 v44, 10, v42
  v_lshrrev_b32 v43, 2, v36
  v_and_b32 v43, 4, v43
  v_xor_b32 v43, v43, v40
  v_lshl_add_u32 v114, v43, 4, v44
  v_lshlrev_b32 v43, 4, v36
  s_cmp_ge_u32 s66, 2
  s_cselect_b64 vcc, -1, 0
  v_cndmask_b32 v114, v114, v43, vcc
  s_and_b32 s70, s25, 0xffff
  s_mov_b32 s4, 8192
  s_mov_b32 s5, 65536
  s_mov_b32 s71, 1409024
  s_cmp_ge_u32 s66, 2
  s_cselect_b32 s44, s48, s24
  s_cselect_b32 s45, s49, s70
  s_cselect_b32 s46, s50, s71
  s_cselect_b32 s4, 1024, s4
  s_cselect_b32 s5, 8192, s5
  s_mov_b32 s47, 0x00020000
  s_mul_i32 s70, s67, 720896
  s_lshl_b32 s71, s66, 15
  s_add_u32 s70, s70, s71
  s_lshl_b32 s71, s62, 7
  s_add_u32 s6, s70, s71
  s_mul_i32 s70, s67, 90112
  s_sub_u32 s71, s66, 2
  s_lshl_b32 s71, s71, 12
  s_add_u32 s70, s70, s71
  s_cmp_ge_u32 s66, 2
  s_cselect_b32 s6, s70, s6
  s_lshl_b32 s7, s67, 14
  s_lshl_b32 s70, s66, 12
  s_add_u32 s7, s7, s70
  s_mul_i32 s9, s65, 11
  s_lshr_b32 s9, s9, 3
  v_lshrrev_b32 v42, 1, v38
  v_lshlrev_b32 v42, 3, v42
  v_lshrrev_b32 v43, 2, v37
  v_add_u32 v42, v42, v43
  v_lshlrev_b32 v42, 7, v42
  v_and_b32 v43, 1, v38
  v_lshlrev_b32 v43, 1, v43
  v_bfe_u32 v44, v37, 1, 1
  v_add_u32 v43, v43, v44
  s_lshl_b32 s70, s69, 2
  v_add_u32 v43, s70, v43
  v_lshrrev_b32 v44, 1, v37
  v_and_b32 v44, 4, v44
  v_xor_b32 v43, v43, v44
  v_lshl_add_u32 v42, v43, 4, v42
  v_and_b32 v43, 1, v37
  v_lshl_add_u32 v42, v43, 3, v42
  s_lshl_b32 s70, s67, 14
  v_add_u32 v115, s70, v42
  v_lshrrev_b32 v42, 5, v36
  v_lshlrev_b32 v42, 10, v42
  v_and_b32 v43, 31, v36
  v_lshl_add_u32 v42, v43, 3, v42
  s_lshl_b32 s70, s67, 14
  s_lshl_b32 s71, s68, 8
  s_add_u32 s70, s70, s71
  s_add_u32 s70, s70, 8192
  v_add_u32 v116, s70, v42
  s_mul_i32 s70, s67, 30096
  v_mul_u32_u24 v42, 528, v37
  v_lshl_add_u32 v42, v38, 4, v42
  v_add_u32 v118, s70, v42
  s_cmp_eq_u32 s66, 2
  s_cselect_b32 s71, 3, s66
  s_mul_i32 s71, s71, 8448
  v_add_u32 v117, s71, v118
  v_lshrrev_b32 v42, 1, v38
  v_lshlrev_b32 v42, 1, v42
  v_xor_b32 v42, v42, v37
  v_lshlrev_b32 v42, 4, v42
  v_lshl_add_u32 v50, v38, 8, v42
  s_lshl_b32 s70, s68, 3
  v_lshrrev_b32 v42, 3, v36
  v_add_u32 v42, s70, v42
  v_lshlrev_b32 v43, 1, v40
  v_xor_b32 v43, v43, v42
  v_lshlrev_b32 v43, 4, v43
  v_lshl_add_u32 v43, v40, 9, v43
  s_mul_i32 s70, s67, 20480
  s_add_u32 s70, s70, 120832
  s_cmp_ge_u32 s66, 2
  s_cselect_b32 s71, 12288, 0
  s_add_u32 s70, s70, s71
  v_add_u32 v119, s70, v43
  s_cmp_ge_u32 s66, 2
  s_cselect_b32 s70, 0, 16
  v_add_u32 v42, s70, v42
  v_lshlrev_b32 v44, 7, v42
  v_lshl_add_u32 v121, v40, 4, v44
  v_add_u32 v42, 16, v42
  v_mul_u32_u24 v42, 144, v42
  v_lshl_add_u32 v42, v40, 4, v42
  v_add_u32 v120, s85, v42
  s_cmp_eq_u32 s67, 0
  s_cselect_b32 s70, 16, 0
  s_lshl_b32 s81, s81, s70
  s_and_b32 s81, s81, 0xffff0000
  s_lshl_b32 s82, s82, s70
  s_and_b32 s82, s82, 0xffff0000
  v_mov_b32 v113, s82
  v_mov_b32 v122, s81
  v_mul_f32 v122, 1069066811, v122
  s_waitcnt vmcnt(6)
  v_lshlrev_b32 v46, 16, v46
  v_exp_f32 v122, v122
  v_mul_f32 v46, 1069066811, v46
  v_lshlrev_b32 v47, 16, v47
  v_exp_f32 v46, v46
  v_lshlrev_b32 v48, 16, v48
  v_lshlrev_b32 v49, 16, v49
  v_cvt_pk_bf16_f32 v122, v122, v46
  v_and_b32 v46, 0xffff0000, v122
  v_lshlrev_b32 v122, 16, v122
  v_mul_f32 v124, v47, v122
  v_mul_f32 v123, v46, v122
  v_add_f32 v42, v122, v122
  v_mul_f32 v123, 0xbfb8aa3b, v123
  v_mul_f32 v124, 1042479491, v124
  v_mul_f32 v48, v48, v42
  v_mul_f32 v49, v49, v42
  s_cmp_eq_u32 s69, 1
  s_cbranch_scc1 F_h1_7
  v_mul_f32 v125, 0x41000000, v123
  v_mul_f32 v126, 0x41000000, v124
  v_mul_f32 v127, 0x43000000, v123
  v_mul_f32 v128, 0x43000000, v124
  v_mul_f32 v129, 0x44800000, v123
  v_mul_f32 v130, 0x44800000, v124
  v_exp_f32 v125, v125
  v_fract_f32 v126, v126
  v_exp_f32 v127, v127
  v_fract_f32 v128, v128
  v_exp_f32 v129, v129
  v_fract_f32 v130, v130
  v_cos_f32 v132, v126
  v_sin_f32 v133, v126
  v_cos_f32 v134, v128
  v_sin_f32 v135, v128
  v_cos_f32 v136, v130
  v_sin_f32 v137, v130
  s_nop 0
  v_mul_f32 v132, v132, v125
  v_mul_f32 v133, v133, v125
  v_mul_f32 v134, v134, v127
  v_mul_f32 v135, v135, v127
  v_mul_f32 v136, v136, v129
  v_mul_f32 v137, v137, v129
  v_mov_b32 v4, 0x00003f80
  v_cvt_pk_bf16_f32 v5, v132, v133
  v_pk_mul_f32 v[142:143], v[132:133], v[132:133] op_sel:[1,1] op_sel_hi:[1,0] neg_lo:[1,0]
  v_pk_fma_f32 v[148:149], v[132:133], v[132:133], v[142:143] op_sel:[0,0,0] op_sel_hi:[0,1,1]
  v_pk_mul_f32 v[144:145], v[48:49], v[136:137] op_sel:[1,1] op_sel_hi:[1,0] neg_lo:[1,0]
  v_pk_fma_f32 v[150:151], v[48:49], v[136:137], v[144:145] op_sel:[0,0,0] op_sel_hi:[0,1,1]
  v_cvt_pk_bf16_f32 v6, v148, v149
  v_cvt_pk_bf16_f32 v20, v150, -v151
  v_mov_b32 v138, v148
  v_mov_b32 v139, v149
  v_pk_mul_f32 v[142:143], v[132:133], v[148:149] op_sel:[1,1] op_sel_hi:[1,0] neg_lo:[1,0]
  v_pk_mul_f32 v[144:145], v[150:151], v[134:135] op_sel:[1,1] op_sel_hi:[1,0] neg_lo:[1,0]
  v_pk_mul_f32 v[146:147], v[138:139], v[148:149] op_sel:[1,1] op_sel_hi:[1,0] neg_lo:[1,0]
  v_pk_fma_f32 v[132:133], v[132:133], v[148:149], v[142:143] op_sel:[0,0,0] op_sel_hi:[0,1,1]
  v_pk_fma_f32 v[150:151], v[150:151], v[134:135], v[144:145] op_sel:[0,0,0] op_sel_hi:[0,1,1]
  v_pk_fma_f32 v[138:139], v[138:139], v[148:149], v[146:147] op_sel:[0,0,0] op_sel_hi:[0,1,1]
  v_cvt_pk_bf16_f32 v7, v132, v133
  v_cvt_pk_bf16_f32 v21, v150, -v151
  v_cvt_pk_bf16_f32 v8, v138, v139
  v_pk_mul_f32 v[142:143], v[132:133], v[148:149] op_sel:[1,1] op_sel_hi:[1,0] neg_lo:[1,0]
  v_pk_mul_f32 v[144:145], v[150:151], v[134:135] op_sel:[1,1] op_sel_hi:[1,0] neg_lo:[1,0]
  v_pk_mul_f32 v[146:147], v[138:139], v[148:149] op_sel:[1,1] op_sel_hi:[1,0] neg_lo:[1,0]
  v_pk_fma_f32 v[132:133], v[132:133], v[148:149], v[142:143] op_sel:[0,0,0] op_sel_hi:[0,1,1]
  v_pk_fma_f32 v[150:151], v[150:151], v[134:135], v[144:145] op_sel:[0,0,0] op_sel_hi:[0,1,1]
  v_pk_fma_f32 v[138:139], v[138:139], v[148:149], v[146:147] op_sel:[0,0,0] op_sel_hi:[0,1,1]
  v_cvt_pk_bf16_f32 v9, v132, v133
  v_cvt_pk_bf16_f32 v22, v150, -v151
  v_cvt_pk_bf16_f32 v10, v138, v139
  v_pk_mul_f32 v[142:143], v[132:133], v[148:149] op_sel:[1,1] op_sel_hi:[1,0] neg_lo:[1,0]
  v_pk_mul_f32 v[144:145], v[150:151], v[134:135] op_sel:[1,1] op_sel_hi:[1,0] neg_lo:[1,0]
  v_pk_mul_f32 v[146:147], v[138:139], v[148:149] op_sel:[1,1] op_sel_hi:[1,0] neg_lo:[1,0]
  v_pk_fma_f32 v[132:133], v[132:133], v[148:149], v[142:143] op_sel:[0,0,0] op_sel_hi:[0,1,1]
  v_pk_fma_f32 v[150:151], v[150:151], v[134:135], v[144:145] op_sel:[0,0,0] op_sel_hi:[0,1,1]
  v_pk_fma_f32 v[138:139], v[138:139], v[148:149], v[146:147] op_sel:[0,0,0] op_sel_hi:[0,1,1]
  v_cvt_pk_bf16_f32 v11, v132, v133
  v_cvt_pk_bf16_f32 v23, v150, -v151
  v_cvt_pk_bf16_f32 v12, v138, v139
  v_pk_mul_f32 v[142:143], v[132:133], v[148:149] op_sel:[1,1] op_sel_hi:[1,0] neg_lo:[1,0]
  v_pk_mul_f32 v[144:145], v[150:151], v[134:135] op_sel:[1,1] op_sel_hi:[1,0] neg_lo:[1,0]
  v_pk_mul_f32 v[146:147], v[138:139], v[148:149] op_sel:[1,1] op_sel_hi:[1,0] neg_lo:[1,0]
  v_pk_fma_f32 v[132:133], v[132:133], v[148:149], v[142:143] op_sel:[0,0,0] op_sel_hi:[0,1,1]
  v_pk_fma_f32 v[150:151], v[150:151], v[134:135], v[144:145] op_sel:[0,0,0] op_sel_hi:[0,1,1]
  v_pk_fma_f32 v[138:139], v[138:139], v[148:149], v[146:147] op_sel:[0,0,0] op_sel_hi:[0,1,1]
  v_cvt_pk_bf16_f32 v13, v132, v133
  v_cvt_pk_bf16_f32 v24, v150, -v151
  v_cvt_pk_bf16_f32 v14, v138, v139
  v_pk_mul_f32 v[142:143], v[132:133], v[148:149] op_sel:[1,1] op_sel_hi:[1,0] neg_lo:[1,0]
  v_pk_mul_f32 v[144:145], v[150:151], v[134:135] op_sel:[1,1] op_sel_hi:[1,0] neg_lo:[1,0]
  v_pk_mul_f32 v[146:147], v[138:139], v[148:149] op_sel:[1,1] op_sel_hi:[1,0] neg_lo:[1,0]
  v_pk_fma_f32 v[132:133], v[132:133], v[148:149], v[142:143] op_sel:[0,0,0] op_sel_hi:[0,1,1]
  v_pk_fma_f32 v[150:151], v[150:151], v[134:135], v[144:145] op_sel:[0,0,0] op_sel_hi:[0,1,1]
  v_pk_fma_f32 v[138:139], v[138:139], v[148:149], v[146:147] op_sel:[0,0,0] op_sel_hi:[0,1,1]
  v_cvt_pk_bf16_f32 v15, v132, v133
  v_cvt_pk_bf16_f32 v25, v150, -v151
  v_cvt_pk_bf16_f32 v16, v138, v139
  v_pk_mul_f32 v[142:143], v[132:133], v[148:149] op_sel:[1,1] op_sel_hi:[1,0] neg_lo:[1,0]
  v_pk_mul_f32 v[144:145], v[150:151], v[134:135] op_sel:[1,1] op_sel_hi:[1,0] neg_lo:[1,0]
  v_pk_mul_f32 v[146:147], v[138:139], v[148:149] op_sel:[1,1] op_sel_hi:[1,0] neg_lo:[1,0]
  v_pk_fma_f32 v[132:133], v[132:133], v[148:149], v[142:143] op_sel:[0,0,0] op_sel_hi:[0,1,1]
  v_pk_fma_f32 v[150:151], v[150:151], v[134:135], v[144:145] op_sel:[0,0,0] op_sel_hi:[0,1,1]
  v_pk_fma_f32 v[138:139], v[138:139], v[148:149], v[146:147] op_sel:[0,0,0] op_sel_hi:[0,1,1]
  v_cvt_pk_bf16_f32 v17, v132, v133
  v_cvt_pk_bf16_f32 v26, v150, -v151
  v_cvt_pk_bf16_f32 v18, v138, v139
  v_pk_mul_f32 v[142:143], v[132:133], v[148:149] op_sel:[1,1] op_sel_hi:[1,0] neg_lo:[1,0]
  v_pk_mul_f32 v[144:145], v[150:151], v[134:135] op_sel:[1,1] op_sel_hi:[1,0] neg_lo:[1,0]
  v_pk_fma_f32 v[132:133], v[132:133], v[148:149], v[142:143] op_sel:[0,0,0] op_sel_hi:[0,1,1]
  v_pk_fma_f32 v[150:151], v[150:151], v[134:135], v[144:145] op_sel:[0,0,0] op_sel_hi:[0,1,1]
  v_cvt_pk_bf16_f32 v19, v132, v133
  v_cvt_pk_bf16_f32 v27, v150, -v151
  v_pk_mul_f32 v[144:145], v[150:151], v[134:135] op_sel:[1,1] op_sel_hi:[1,0] neg_lo:[1,0]
  v_pk_fma_f32 v[150:151], v[150:151], v[134:135], v[144:145] op_sel:[0,0,0] op_sel_hi:[0,1,1]
  v_cvt_pk_bf16_f32 v28, v150, -v151
  s_branch F_gen_done_8
F_h1_7:
  v_mul_f32 v125, 0x3f800000, v123
  v_mul_f32 v126, 0x3f800000, v124
  v_mul_f32 v127, 0x43000000, v123
  v_mul_f32 v128, 0x43000000, v124
  v_exp_f32 v125, v125
  v_fract_f32 v126, v126
  v_exp_f32 v127, v127
  v_fract_f32 v128, v128
  v_cos_f32 v132, v126
  v_sin_f32 v133, v126
  v_cos_f32 v134, v128
  v_sin_f32 v135, v128
  s_nop 0
  v_mul_f32 v132, v132, v125
  v_mul_f32 v133, v133, v125
  v_mul_f32 v134, v134, v127
  v_mul_f32 v135, v135, v127
  v_pk_mul_f32 v[142:143], v[134:135], v[134:135] op_sel:[1,1] op_sel_hi:[1,0] neg_lo:[1,0]
  v_pk_fma_f32 v[136:137], v[134:135], v[134:135], v[142:143] op_sel:[0,0,0] op_sel_hi:[0,1,1]
  v_mov_b32 v148, v48
  v_mov_b32 v149, v49
  v_cvt_pk_bf16_f32 v4, v148, -v149
  v_pk_mul_f32 v[142:143], v[148:149], v[132:133] op_sel:[1,1] op_sel_hi:[1,0] neg_lo:[1,0]
  v_pk_mul_f32 v[144:145], v[148:149], v[134:135] op_sel:[1,1] op_sel_hi:[1,0] neg_lo:[1,0]
  v_pk_fma_f32 v[150:151], v[148:149], v[132:133], v[142:143] op_sel:[0,0,0] op_sel_hi:[0,1,1]
  v_pk_fma_f32 v[138:139], v[148:149], v[134:135], v[144:145] op_sel:[0,0,0] op_sel_hi:[0,1,1]
  v_cvt_pk_bf16_f32 v5, v150, -v151
  v_cvt_pk_bf16_f32 v12, v138, -v139
  v_pk_mul_f32 v[142:143], v[150:151], v[132:133] op_sel:[1,1] op_sel_hi:[1,0] neg_lo:[1,0]
  v_pk_mul_f32 v[144:145], v[150:151], v[134:135] op_sel:[1,1] op_sel_hi:[1,0] neg_lo:[1,0]
  v_pk_fma_f32 v[152:153], v[150:151], v[132:133], v[142:143] op_sel:[0,0,0] op_sel_hi:[0,1,1]
  v_pk_fma_f32 v[140:141], v[150:151], v[134:135], v[144:145] op_sel:[0,0,0] op_sel_hi:[0,1,1]
  v_cvt_pk_bf16_f32 v6, v152, -v153
  v_cvt_pk_bf16_f32 v13, v140, -v141
  v_pk_mul_f32 v[142:143], v[152:153], v[132:133] op_sel:[1,1] op_sel_hi:[1,0] neg_lo:[1,0]
  v_pk_mul_f32 v[144:145], v[152:153], v[134:135] op_sel:[1,1] op_sel_hi:[1,0] neg_lo:[1,0]
  v_pk_fma_f32 v[154:155], v[152:153], v[132:133], v[142:143] op_sel:[0,0,0] op_sel_hi:[0,1,1]
  v_pk_fma_f32 v[138:139], v[152:153], v[134:135], v[144:145] op_sel:[0,0,0] op_sel_hi:[0,1,1]
  v_cvt_pk_bf16_f32 v7, v154, -v155
  v_cvt_pk_bf16_f32 v14, v138, -v139
  v_pk_mul_f32 v[142:143], v[154:155], v[132:133] op_sel:[1,1] op_sel_hi:[1,0] neg_lo:[1,0]
  v_pk_mul_f32 v[144:145], v[154:155], v[134:135] op_sel:[1,1] op_sel_hi:[1,0] neg_lo:[1,0]
  v_pk_fma_f32 v[156:157], v[154:155], v[132:133], v[142:143] op_sel:[0,0,0] op_sel_hi:[0,1,1]
  v_pk_fma_f32 v[140:141], v[154:155], v[134:135], v[144:145] op_sel:[0,0,0] op_sel_hi:[0,1,1]
  v_cvt_pk_bf16_f32 v8, v156, -v157
  v_cvt_pk_bf16_f32 v15, v140, -v141
  v_pk_mul_f32 v[142:143], v[156:157], v[132:133] op_sel:[1,1] op_sel_hi:[1,0] neg_lo:[1,0]
  v_pk_mul_f32 v[144:145], v[156:157], v[134:135] op_sel:[1,1] op_sel_hi:[1,0] neg_lo:[1,0]
  v_pk_fma_f32 v[158:159], v[156:157], v[132:133], v[142:143] op_sel:[0,0,0] op_sel_hi:[0,1,1]
  v_pk_fma_f32 v[138:139], v[156:157], v[134:135], v[144:145] op_sel:[0,0,0] op_sel_hi:[0,1,1]
  v_cvt_pk_bf16_f32 v9, v158, -v159
  v_cvt_pk_bf16_f32 v16, v138, -v139
  v_pk_mul_f32 v[142:143], v[158:159], v[132:133] op_sel:[1,1] op_sel_hi:[1,0] neg_lo:[1,0]
  v_pk_mul_f32 v[144:145], v[158:159], v[134:135] op_sel:[1,1] op_sel_hi:[1,0] neg_lo:[1,0]
  v_pk_fma_f32 v[160:161], v[158:159], v[132:133], v[142:143] op_sel:[0,0,0] op_sel_hi:[0,1,1]
  v_pk_fma_f32 v[140:141], v[158:159], v[134:135], v[144:145] op_sel:[0,0,0] op_sel_hi:[0,1,1]
  v_cvt_pk_bf16_f32 v10, v160, -v161
  v_cvt_pk_bf16_f32 v17, v140, -v141
  v_pk_mul_f32 v[142:143], v[160:161], v[132:133] op_sel:[1,1] op_sel_hi:[1,0] neg_lo:[1,0]
  v_pk_mul_f32 v[144:145], v[160:161], v[134:135] op_sel:[1,1] op_sel_hi:[1,0] neg_lo:[1,0]
  v_pk_fma_f32 v[162:163], v[160:161], v[132:133], v[142:143] op_sel:[0,0,0] op_sel_hi:[0,1,1]
  v_pk_fma_f32 v[138:139], v[160:161], v[134:135], v[144:145] op_sel:[0,0,0] op_sel_hi:[0,1,1]
  v_cvt_pk_bf16_f32 v11, v162, -v163
  v_cvt_pk_bf16_f32 v18, v138, -v139
  v_pk_mul_f32 v[142:143], v[162:163], v[134:135] op_sel:[1,1] op_sel_hi:[1,0] neg_lo:[1,0]
  v_pk_mul_f32 v[144:145], v[136:137], v[136:137] op_sel:[1,1] op_sel_hi:[1,0] neg_lo:[1,0]
  v_pk_fma_f32 v[138:139], v[162:163], v[134:135], v[142:143] op_sel:[0,0,0] op_sel_hi:[0,1,1]
  v_pk_fma_f32 v[132:133], v[136:137], v[136:137], v[144:145] op_sel:[0,0,0] op_sel_hi:[0,1,1]
  v_cvt_pk_bf16_f32 v19, v138, -v139
  v_pk_mul_f32 v[142:143], v[148:149], v[136:137] op_sel:[1,1] op_sel_hi:[1,0] neg_lo:[1,0]
  v_pk_mul_f32 v[144:145], v[152:153], v[136:137] op_sel:[1,1] op_sel_hi:[1,0] neg_lo:[1,0]
  v_pk_fma_f32 v[138:139], v[148:149], v[136:137], v[142:143] op_sel:[0,0,0] op_sel_hi:[0,1,1]
  v_pk_fma_f32 v[140:141], v[152:153], v[136:137], v[144:145] op_sel:[0,0,0] op_sel_hi:[0,1,1]
  v_cvt_pk_bf16_f32 v20, v138, -v139
  v_cvt_pk_bf16_f32 v21, v140, -v141
  v_pk_mul_f32 v[142:143], v[138:139], v[134:135] op_sel:[1,1] op_sel_hi:[1,0] neg_lo:[1,0]
  v_pk_mul_f32 v[144:145], v[140:141], v[134:135] op_sel:[1,1] op_sel_hi:[1,0] neg_lo:[1,0]
  v_pk_fma_f32 v[138:139], v[138:139], v[134:135], v[142:143] op_sel:[0,0,0] op_sel_hi:[0,1,1]
  v_pk_fma_f32 v[140:141], v[140:141], v[134:135], v[144:145] op_sel:[0,0,0] op_sel_hi:[0,1,1]
  v_cvt_pk_bf16_f32 v24, v138, -v139
  v_cvt_pk_bf16_f32 v25, v140, -v141
  v_pk_mul_f32 v[142:143], v[156:157], v[136:137] op_sel:[1,1] op_sel_hi:[1,0] neg_lo:[1,0]
  v_pk_mul_f32 v[144:145], v[160:161], v[136:137] op_sel:[1,1] op_sel_hi:[1,0] neg_lo:[1,0]
  v_pk_fma_f32 v[138:139], v[156:157], v[136:137], v[142:143] op_sel:[0,0,0] op_sel_hi:[0,1,1]
  v_pk_fma_f32 v[140:141], v[160:161], v[136:137], v[144:145] op_sel:[0,0,0] op_sel_hi:[0,1,1]
  v_cvt_pk_bf16_f32 v22, v138, -v139
  v_cvt_pk_bf16_f32 v23, v140, -v141
  v_pk_mul_f32 v[142:143], v[138:139], v[134:135] op_sel:[1,1] op_sel_hi:[1,0] neg_lo:[1,0]
  v_pk_mul_f32 v[144:145], v[140:141], v[134:135] op_sel:[1,1] op_sel_hi:[1,0] neg_lo:[1,0]
  v_pk_fma_f32 v[138:139], v[138:139], v[134:135], v[142:143] op_sel:[0,0,0] op_sel_hi:[0,1,1]
  v_pk_fma_f32 v[140:141], v[140:141], v[134:135], v[144:145] op_sel:[0,0,0] op_sel_hi:[0,1,1]
  v_cvt_pk_bf16_f32 v26, v138, -v139
  v_cvt_pk_bf16_f32 v27, v140, -v141
  v_pk_mul_f32 v[142:143], v[148:149], v[132:133] op_sel:[1,1] op_sel_hi:[1,0] neg_lo:[1,0]
  v_pk_mul_f32 v[144:145], v[156:157], v[132:133] op_sel:[1,1] op_sel_hi:[1,0] neg_lo:[1,0]
  v_pk_fma_f32 v[138:139], v[148:149], v[132:133], v[142:143] op_sel:[0,0,0] op_sel_hi:[0,1,1]
  v_pk_fma_f32 v[140:141], v[156:157], v[132:133], v[144:145] op_sel:[0,0,0] op_sel_hi:[0,1,1]
  v_cvt_pk_bf16_f32 v28, v138, -v139
  v_cvt_pk_bf16_f32 v29, v140, -v141
  v_pk_mul_f32 v[142:143], v[138:139], v[134:135] op_sel:[1,1] op_sel_hi:[1,0] neg_lo:[1,0]
  v_pk_mul_f32 v[144:145], v[140:141], v[134:135] op_sel:[1,1] op_sel_hi:[1,0] neg_lo:[1,0]
  v_pk_fma_f32 v[138:139], v[138:139], v[134:135], v[142:143] op_sel:[0,0,0] op_sel_hi:[0,1,1]
  v_pk_fma_f32 v[140:141], v[140:141], v[134:135], v[144:145] op_sel:[0,0,0] op_sel_hi:[0,1,1]
  v_cvt_pk_bf16_f32 v30, v138, -v139
  v_cvt_pk_bf16_f32 v31, v140, -v141
  v_pk_mul_f32 v[142:143], v[138:139], v[134:135] op_sel:[1,1] op_sel_hi:[1,0] neg_lo:[1,0]
  v_pk_mul_f32 v[144:145], v[140:141], v[134:135] op_sel:[1,1] op_sel_hi:[1,0] neg_lo:[1,0]
  v_pk_fma_f32 v[138:139], v[138:139], v[134:135], v[142:143] op_sel:[0,0,0] op_sel_hi:[0,1,1]
  v_pk_fma_f32 v[140:141], v[140:141], v[134:135], v[144:145] op_sel:[0,0,0] op_sel_hi:[0,1,1]
  v_cvt_pk_bf16_f32 v32, v138, -v139
  v_cvt_pk_bf16_f32 v33, v140, -v141
  v_pk_mul_f32 v[142:143], v[138:139], v[134:135] op_sel:[1,1] op_sel_hi:[1,0] neg_lo:[1,0]
  v_pk_mul_f32 v[144:145], v[140:141], v[134:135] op_sel:[1,1] op_sel_hi:[1,0] neg_lo:[1,0]
  v_pk_fma_f32 v[138:139], v[138:139], v[134:135], v[142:143] op_sel:[0,0,0] op_sel_hi:[0,1,1]
  v_pk_fma_f32 v[140:141], v[140:141], v[134:135], v[144:145] op_sel:[0,0,0] op_sel_hi:[0,1,1]
  v_cvt_pk_bf16_f32 v34, v138, -v139
  v_cvt_pk_bf16_f32 v35, v140, -v141
F_gen_done_8:
  v_mov_b32 v124, 1065369472
  v_mov_b32 v125, 1065369472
  v_mov_b32 v126, 1065369472
  v_mov_b32 v127, 1065369472
  v_mov_b32 v128, 0
  v_mov_b32 v129, 0
  s_waitcnt vmcnt(5)
  v_dot2_f32_bf16 v128, v64, v124, v128
  v_dot2_f32_bf16 v129, v64, v64, v129
  v_dot2_f32_bf16 v128, v65, v124, v128
  v_dot2_f32_bf16 v129, v65, v65, v129
  v_dot2_f32_bf16 v128, v66, v124, v128
  v_dot2_f32_bf16 v129, v66, v66, v129
  v_dot2_f32_bf16 v128, v67, v124, v128
  v_dot2_f32_bf16 v129, v67, v67, v129
  s_nop 2
  v_add_f32_dpp v128, v128, v128 quad_perm:[1,0,3,2] row_mask:0xf bank_mask:0xf
  v_add_f32_dpp v129, v129, v129 quad_perm:[1,0,3,2] row_mask:0xf bank_mask:0xf
  s_nop 0
  v_add_f32_dpp v128, v128, v128 quad_perm:[2,3,0,1] row_mask:0xf bank_mask:0xf
  v_add_f32_dpp v129, v129, v129 quad_perm:[2,3,0,1] row_mask:0xf bank_mask:0xf
  s_nop 0
  v_add_f32_dpp v128, v128, v128 row_half_mirror row_mask:0xf bank_mask:0xf
  v_add_f32_dpp v129, v129, v129 row_half_mirror row_mask:0xf bank_mask:0xf
  s_nop 0
  v_add_f32_dpp v128, v128, v128 row_mirror row_mask:0xf bank_mask:0xf
  v_add_f32_dpp v129, v129, v129 row_mirror row_mask:0xf bank_mask:0xf
  s_nop 0
  v_mov_b32 v42, v128
  v_mov_b32 v43, v129
  s_nop 0
  v_permlane16_swap_b32 v128, v42
  v_permlane16_swap_b32 v129, v43
  s_nop 0
  v_add_f32 v128, v128, v42
  v_add_f32 v129, v129, v43
  v_mov_b32 v42, v128
  v_mov_b32 v43, v129
  s_nop 0
  v_permlane32_swap_b32 v128, v42
  v_permlane32_swap_b32 v129, v43
  s_nop 0
  v_add_f32 v128, v128, v42
  v_add_f32 v129, v129, v43
  v_mul_f32 v128, 0x3b000000, v128
  v_mul_f32 v129, 0x3b000000, v129
  v_fma_f32 v129, -v128, v128, v129
  v_max_f32 v129, 0, v129
  v_cvt_pk_bf16_f32 v42, v128, v129
  v_and_b32 v129, 0xffff0000, v42
  v_lshlrev_b32 v128, 16, v42
  v_add_f32 v129, 0x3727c5ac, v129
  v_cvt_pk_bf16_f32 v129, v129, v129
  v_and_b32 v129, 0xffff0000, v129
  v_sqrt_f32 v129, v129
  s_lshl_b32 s71, s88, 4
  s_add_u32 s71, s71, 12713984
  v_cvt_pk_bf16_f32 v129, v129, v129
  v_and_b32 v129, 0xffff0000, v129
  v_rcp_f32 v132, v129
  s_waitcnt vmcnt(0)
  v_cmp_eq_u32 vcc, 0, v56
  s_cbranch_vccnz F_slow_9
F_back_10:
  s_mul_i32 s77, s76, 176128
  s_lshl_b32 s78, s76, 7
  s_add_u32 s77, s77, s74
  s_add_u32 s78, s78, s73
  s_add_u32 s76, s76, 1
  s_and_b32 s76, s76, 7
  s_add_u32 m0, s75, 57344
  s_nop 0
  buffer_load_dwordx4 v53, s[36:39], s78 offen lds
  s_add_u32 m0, s75, 32768
  s_nop 0
  buffer_load_dwordx4 v51, s[40:43], s77 offen lds
  s_add_u32 m0, s75, 40960
  s_add_u32 s77, s77, 128
  buffer_load_dwordx4 v51, s[40:43], s77 offen lds
  s_add_u32 m0, s75, 49152
  s_add_u32 s77, s77, 128
  buffer_load_dwordx4 v52, s[40:43], s77 offen lds
  v_mul_f32_e64 v133, -v128, v132
  v_mov_b32 v134, v56
  v_mov_b32 v135, v57
  v_mov_b32 v43, 0
  s_mov_b64 exec, 1
  buffer_store_dwordx4 v[132:135], v43, s[52:55], s71 offen sc1
  s_mov_b64 exec, -1
  s_waitcnt lgkmcnt(0)
  v_add_u32 v248, 65536, v68
  v_add_u32 v249, 65536, v69
  v_add_u32 v250, 65536, v70
  v_add_u32 v251, 65536, v71
  v_add_u32 v252, 65536, v72
  v_add_u32 v253, 65536, v73
  v_add_u32 v254, 65536, v74
  v_add_u32 v255, 65536, v75
  s_mov_b32 s14, 0x05040100
  s_mov_b32 s15, 0x07060302
  v_mov_b32 v42, 0
  ds_write_b32 v105, v42
  v_lshlrev_b32 v43, 2, v37
  v_add_u32 v43, 162816, v43
  ds_write_b32 v43, v42
  v_mov_b32 v46, 162816
  s_lshl_b32 s70, s67, 4
  v_add_u32 v47, s70, v46
  v_mov_b32 v48, 1
  s_waitcnt lgkmcnt(0)
  s_waitcnt vmcnt(5)
  s_barrier
  ds_read_b128 v[200:203], v74 offset:0
  ds_read_b64_tr_b16 v[176:177], v68 offset:0
  ds_read_b64_tr_b16 v[178:179], v68 offset:512
  ds_read_b128 v[204:207], v74 offset:2048
  ds_read_b64_tr_b16 v[180:181], v69 offset:0
  ds_read_b64_tr_b16 v[182:183], v69 offset:512
  ds_read_b64_tr_b16 v[184:185], v70 offset:0
  ds_read_b64_tr_b16 v[186:187], v70 offset:512
  s_cmp_eq_u32 s67, 1
  s_cbranch_scc1 F_g1v1_11
  s_waitcnt lgkmcnt(0)
  v_mfma_f32_16x16x32_bf16 v[140:143], v[176:179], v[200:203], 0
  ds_read_b128 v[208:211], v75 offset:0
  ds_read_b64_tr_b16 v[188:189], v71 offset:0
  s_mul_i32 s77, s76, 176128
  s_lshl_b32 s78, s76, 7
  s_add_u32 s77, s77, s74
  s_add_u32 s78, s78, s73
  s_add_u32 s76, s76, 1
  s_and_b32 s76, s76, 7
  s_add_u32 m0, s75, 90112
  s_nop 0
  buffer_load_dwordx4 v53, s[36:39], s78 offen lds
  v_mfma_f32_16x16x32_bf16 v[144:147], v[176:179], v[204:207], 0
  ds_read_b64_tr_b16 v[190:191], v71 offset:512
  ds_read_b128 v[212:215], v75 offset:2048
  v_mfma_f32_16x16x32_bf16 v[148:151], v[180:183], v[200:203], 0
  ds_read_b64_tr_b16 v[192:193], v72 offset:0
  ds_read_b64_tr_b16 v[194:195], v72 offset:512
  s_add_u32 m0, s75, 65536
  s_nop 0
  buffer_load_dwordx4 v51, s[40:43], s77 offen lds
  v_mfma_f32_16x16x32_bf16 v[152:155], v[180:183], v[204:207], 0
  ds_read_b64_tr_b16 v[196:197], v73 offset:0
  ds_read_b64_tr_b16 v[198:199], v73 offset:512
  v_mfma_f32_16x16x32_bf16 v[156:159], v[184:187], v[200:203], 0
  s_add_u32 m0, s75, 73728
  s_add_u32 s77, s77, 128
  buffer_load_dwordx4 v51, s[40:43], s77 offen lds
  v_mfma_f32_16x16x32_bf16 v[160:163], v[184:187], v[204:207], 0
  v_mfma_f32_16x16x32_bf16 v[164:167], v[176:179], v[124:127], 0
  s_add_u32 m0, s75, 81920
  s_add_u32 s77, s77, 128
  buffer_load_dwordx4 v52, s[40:43], s77 offen lds
  v_mfma_f32_16x16x32_bf16 v[168:171], v[180:183], v[124:127], 0
  v_mfma_f32_16x16x32_bf16 v[172:175], v[184:187], v[124:127], 0
  s_lshl_b32 s70, s62, 7
  s_add_u32 s70, s70, s73
  s_add_u32 m0, s75, 131072
  s_nop 0
  buffer_load_dwordx4 v53, s[36:39], s70 offen lds
  s_waitcnt lgkmcnt(0)
  s_waitcnt vmcnt(6)
  s_barrier
  v_mfma_f32_16x16x32_bf16 v[140:143], v[188:191], v[208:211], v[140:143]
  ds_read_b128 v[200:203], v74 offset:32768
  ds_read_b64_tr_b16 v[176:177], v68 offset:32768
  global_load_dwordx2 v[76:77], v101, s[22:23]
  global_load_dwordx2 v[78:79], v102, s[22:23]
  global_load_dwordx2 v[80:81], v103, s[22:23]
  v_mfma_f32_16x16x32_bf16 v[144:147], v[188:191], v[212:215], v[144:147]
  ds_read_b64_tr_b16 v[178:179], v68 offset:33280
  ds_read_b128 v[204:207], v74 offset:34816
  s_mul_i32 s77, s76, 176128
  s_lshl_b32 s78, s76, 7
  s_add_u32 s77, s77, s74
  s_add_u32 s78, s78, s73
  s_add_u32 s76, s76, 1
  s_and_b32 s76, s76, 7
  s_add_u32 m0, s75, 122880
  s_nop 0
  buffer_load_dwordx4 v53, s[36:39], s78 offen lds
  v_mfma_f32_16x16x32_bf16 v[148:151], v[192:195], v[208:211], v[148:151]
  ds_read_b64_tr_b16 v[180:181], v69 offset:32768
  ds_read_b64_tr_b16 v[182:183], v69 offset:33280
  s_add_u32 m0, s75, 98304
  s_nop 0
  buffer_load_dwordx4 v51, s[40:43], s77 offen lds
  v_mfma_f32_16x16x32_bf16 v[152:155], v[192:195], v[212:215], v[152:155]
  ds_read_b64_tr_b16 v[184:185], v70 offset:32768
  ds_read_b64_tr_b16 v[186:187], v70 offset:33280
  s_add_u32 m0, s75, 106496
  s_add_u32 s77, s77, 128
  buffer_load_dwordx4 v51, s[40:43], s77 offen lds
  v_mfma_f32_16x16x32_bf16 v[156:159], v[196:199], v[208:211], v[156:159]
  s_add_u32 m0, s75, 114688
  s_add_u32 s77, s77, 128
  buffer_load_dwordx4 v52, s[40:43], s77 offen lds
  v_mfma_f32_16x16x32_bf16 v[160:163], v[196:199], v[212:215], v[160:163]
  v_mfma_f32_16x16x32_bf16 v[164:167], v[188:191], v[124:127], v[164:167]
  v_mfma_f32_16x16x32_bf16 v[168:171], v[192:195], v[124:127], v[168:171]
  v_mfma_f32_16x16x32_bf16 v[172:175], v[196:199], v[124:127], v[172:175]
  s_waitcnt vmcnt(8)
  s_barrier
  s_mul_i32 s77, s76, 176128
  s_lshl_b32 s78, s76, 7
  s_add_u32 s77, s77, s74
  s_add_u32 s78, s78, s73
  s_add_u32 s76, s76, 1
  s_and_b32 s76, s76, 7
  s_waitcnt lgkmcnt(0)
  v_mfma_f32_16x16x32_bf16 v[140:143], v[176:179], v[200:203], v[140:143]
  ds_read_b128 v[208:211], v75 offset:32768
  ds_read_b64_tr_b16 v[188:189], v71 offset:32768
  s_add_u32 m0, s75, 24576
  s_nop 0
  buffer_load_dwordx4 v53, s[36:39], s78 offen lds
  v_mfma_f32_16x16x32_bf16 v[144:147], v[176:179], v[204:207], v[144:147]
  ds_read_b64_tr_b16 v[190:191], v71 offset:33280
  ds_read_b128 v[212:215], v75 offset:34816
  v_mfma_f32_16x16x32_bf16 v[148:151], v[180:183], v[200:203], v[148:151]
  ds_read_b64_tr_b16 v[192:193], v72 offset:32768
  ds_read_b64_tr_b16 v[194:195], v72 offset:33280
  s_add_u32 m0, s75, 0
  s_nop 0
  buffer_load_dwordx4 v51, s[40:43], s77 offen lds
  v_mfma_f32_16x16x32_bf16 v[152:155], v[180:183], v[204:207], v[152:155]
  ds_read_b64_tr_b16 v[196:197], v73 offset:32768
  ds_read_b64_tr_b16 v[198:199], v73 offset:33280
  v_mfma_f32_16x16x32_bf16 v[156:159], v[184:187], v[200:203], v[156:159]
  s_add_u32 m0, s75, 8192
  s_add_u32 s77, s77, 128
  buffer_load_dwordx4 v51, s[40:43], s77 offen lds
  v_mfma_f32_16x16x32_bf16 v[160:163], v[184:187], v[204:207], v[160:163]
  v_mfma_f32_16x16x32_bf16 v[164:167], v[176:179], v[124:127], v[164:167]
  s_add_u32 m0, s75, 16384
  s_add_u32 s77, s77, 128
  buffer_load_dwordx4 v52, s[40:43], s77 offen lds
  v_mfma_f32_16x16x32_bf16 v[168:171], v[180:183], v[124:127], v[168:171]
  v_mfma_f32_16x16x32_bf16 v[172:175], v[184:187], v[124:127], v[172:175]
  s_waitcnt lgkmcnt(0)
  v_mfma_f32_16x16x32_bf16 v[140:143], v[188:191], v[208:211], v[140:143]
  ds_read_b128 v[200:203], v254 offset:0
  ds_read_b64_tr_b16 v[176:177], v248 offset:0
  v_mfma_f32_16x16x32_bf16 v[144:147], v[188:191], v[212:215], v[144:147]
  ds_read_b64_tr_b16 v[178:179], v248 offset:512
  ds_read_b128 v[204:207], v254 offset:2048
  v_mfma_f32_16x16x32_bf16 v[148:151], v[192:195], v[208:211], v[148:151]
  ds_read_b64_tr_b16 v[180:181], v249 offset:0
  ds_read_b64_tr_b16 v[182:183], v249 offset:512
  v_mfma_f32_16x16x32_bf16 v[152:155], v[192:195], v[212:215], v[152:155]
  ds_read_b64_tr_b16 v[184:185], v250 offset:0
  ds_read_b64_tr_b16 v[186:187], v250 offset:512
  v_mfma_f32_16x16x32_bf16 v[156:159], v[196:199], v[208:211], v[156:159]
  v_mfma_f32_16x16x32_bf16 v[160:163], v[196:199], v[212:215], v[160:163]
  buffer_load_dwordx4 v[244:247], v110, s[52:55], 0 offen sc1
  v_mfma_f32_16x16x32_bf16 v[164:167], v[188:191], v[124:127], v[164:167]
  v_mfma_f32_16x16x32_bf16 v[168:171], v[192:195], v[124:127], v[168:171]
  v_mfma_f32_16x16x32_bf16 v[172:175], v[196:199], v[124:127], v[172:175]
  s_waitcnt vmcnt(5)
  s_barrier
  s_mul_i32 s77, s76, 176128
  s_lshl_b32 s78, s76, 7
  s_add_u32 s77, s77, s74
  s_add_u32 s78, s78, s73
  s_add_u32 s76, s76, 1
  s_and_b32 s76, s76, 7
  s_waitcnt lgkmcnt(0)
  v_mfma_f32_16x16x32_bf16 v[140:143], v[176:179], v[200:203], v[140:143]
  ds_read_b128 v[208:211], v255 offset:0
  ds_read_b64_tr_b16 v[188:189], v251 offset:0
  s_add_u32 m0, s75, 57344
  s_nop 0
  buffer_load_dwordx4 v53, s[36:39], s78 offen lds
  v_mfma_f32_16x16x32_bf16 v[144:147], v[176:179], v[204:207], v[144:147]
  ds_read_b64_tr_b16 v[190:191], v251 offset:512
  ds_read_b128 v[212:215], v255 offset:2048
  v_mfma_f32_16x16x32_bf16 v[148:151], v[180:183], v[200:203], v[148:151]
  ds_read_b64_tr_b16 v[192:193], v252 offset:0
  ds_read_b64_tr_b16 v[194:195], v252 offset:512
  s_add_u32 m0, s75, 32768
  s_nop 0
  buffer_load_dwordx4 v51, s[40:43], s77 offen lds
  v_mfma_f32_16x16x32_bf16 v[152:155], v[180:183], v[204:207], v[152:155]
  ds_read_b64_tr_b16 v[196:197], v253 offset:0
  ds_read_b64_tr_b16 v[198:199], v253 offset:512
  v_mfma_f32_16x16x32_bf16 v[156:159], v[184:187], v[200:203], v[156:159]
  s_add_u32 m0, s75, 40960
  s_add_u32 s77, s77, 128
  buffer_load_dwordx4 v51, s[40:43], s77 offen lds
  v_mfma_f32_16x16x32_bf16 v[160:163], v[184:187], v[204:207], v[160:163]
  v_mfma_f32_16x16x32_bf16 v[164:167], v[176:179], v[124:127], v[164:167]
  s_add_u32 m0, s75, 49152
  s_add_u32 s77, s77, 128
  buffer_load_dwordx4 v52, s[40:43], s77 offen lds
  v_mfma_f32_16x16x32_bf16 v[168:171], v[180:183], v[124:127], v[168:171]
  v_mfma_f32_16x16x32_bf16 v[172:175], v[184:187], v[124:127], v[172:175]
  s_waitcnt lgkmcnt(0)
  v_mfma_f32_16x16x32_bf16 v[140:143], v[188:191], v[208:211], v[140:143]
  ds_read_b128 v[200:203], v254 offset:32768
  ds_read_b64_tr_b16 v[176:177], v248 offset:32768
  v_mfma_f32_16x16x32_bf16 v[144:147], v[188:191], v[212:215], v[144:147]
  ds_read_b64_tr_b16 v[178:179], v248 offset:33280
  ds_read_b128 v[204:207], v254 offset:34816
  v_mfma_f32_16x16x32_bf16 v[148:151], v[192:195], v[208:211], v[148:151]
  ds_read_b64_tr_b16 v[180:181], v249 offset:32768
  ds_read_b64_tr_b16 v[182:183], v249 offset:33280
  v_mfma_f32_16x16x32_bf16 v[152:155], v[192:195], v[212:215], v[152:155]
  ds_read_b64_tr_b16 v[184:185], v250 offset:32768
  ds_read_b64_tr_b16 v[186:187], v250 offset:33280
  v_mfma_f32_16x16x32_bf16 v[156:159], v[196:199], v[208:211], v[156:159]
  v_mfma_f32_16x16x32_bf16 v[160:163], v[196:199], v[212:215], v[160:163]
  v_mfma_f32_16x16x32_bf16 v[164:167], v[188:191], v[124:127], v[164:167]
  v_mfma_f32_16x16x32_bf16 v[168:171], v[192:195], v[124:127], v[168:171]
  v_mfma_f32_16x16x32_bf16 v[172:175], v[196:199], v[124:127], v[172:175]
  s_waitcnt vmcnt(5)
  s_barrier
  s_mul_i32 s77, s76, 176128
  s_lshl_b32 s78, s76, 7
  s_add_u32 s77, s77, s74
  s_add_u32 s78, s78, s73
  s_add_u32 s76, s76, 1
  s_and_b32 s76, s76, 7
  s_waitcnt lgkmcnt(0)
  v_mfma_f32_16x16x32_bf16 v[140:143], v[176:179], v[200:203], v[140:143]
  ds_read_b128 v[208:211], v255 offset:32768
  ds_read_b64_tr_b16 v[188:189], v251 offset:32768
  s_add_u32 m0, s75, 90112
  s_nop 0
  buffer_load_dwordx4 v53, s[36:39], s78 offen lds
  v_mfma_f32_16x16x32_bf16 v[144:147], v[176:179], v[204:207], v[144:147]
  ds_read_b64_tr_b16 v[190:191], v251 offset:33280
  ds_read_b128 v[212:215], v255 offset:34816
  v_mfma_f32_16x16x32_bf16 v[148:151], v[180:183], v[200:203], v[148:151]
  ds_read_b64_tr_b16 v[192:193], v252 offset:32768
  ds_read_b64_tr_b16 v[194:195], v252 offset:33280
  s_add_u32 m0, s75, 65536
  s_nop 0
  buffer_load_dwordx4 v51, s[40:43], s77 offen lds
  v_mfma_f32_16x16x32_bf16 v[152:155], v[180:183], v[204:207], v[152:155]
  ds_read_b64_tr_b16 v[196:197], v253 offset:32768
  ds_read_b64_tr_b16 v[198:199], v253 offset:33280
  v_mfma_f32_16x16x32_bf16 v[156:159], v[184:187], v[200:203], v[156:159]
  s_add_u32 m0, s75, 73728
  s_add_u32 s77, s77, 128
  buffer_load_dwordx4 v51, s[40:43], s77 offen lds
  v_mfma_f32_16x16x32_bf16 v[160:163], v[184:187], v[204:207], v[160:163]
  v_mfma_f32_16x16x32_bf16 v[164:167], v[176:179], v[124:127], v[164:167]
  s_add_u32 m0, s75, 81920
  s_add_u32 s77, s77, 128
  buffer_load_dwordx4 v52, s[40:43], s77 offen lds
  v_mfma_f32_16x16x32_bf16 v[168:171], v[180:183], v[124:127], v[168:171]
  v_mfma_f32_16x16x32_bf16 v[172:175], v[184:187], v[124:127], v[172:175]
  s_waitcnt lgkmcnt(0)
  v_mfma_f32_16x16x32_bf16 v[140:143], v[188:191], v[208:211], v[140:143]
  ds_read_b128 v[200:203], v74 offset:0
  ds_read_b64_tr_b16 v[176:177], v68 offset:0
  v_mfma_f32_16x16x32_bf16 v[144:147], v[188:191], v[212:215], v[144:147]
  ds_read_b64_tr_b16 v[178:179], v68 offset:512
  ds_read_b128 v[204:207], v74 offset:2048
  v_mfma_f32_16x16x32_bf16 v[148:151], v[192:195], v[208:211], v[148:151]
  ds_read_b64_tr_b16 v[180:181], v69 offset:0
  ds_read_b64_tr_b16 v[182:183], v69 offset:512
  v_mfma_f32_16x16x32_bf16 v[152:155], v[192:195], v[212:215], v[152:155]
  ds_read_b64_tr_b16 v[184:185], v70 offset:0
  ds_read_b64_tr_b16 v[186:187], v70 offset:512
  v_mfma_f32_16x16x32_bf16 v[156:159], v[196:199], v[208:211], v[156:159]
  v_mfma_f32_16x16x32_bf16 v[160:163], v[196:199], v[212:215], v[160:163]
  v_mfma_f32_16x16x32_bf16 v[164:167], v[188:191], v[124:127], v[164:167]
  v_mfma_f32_16x16x32_bf16 v[168:171], v[192:195], v[124:127], v[168:171]
  v_mfma_f32_16x16x32_bf16 v[172:175], v[196:199], v[124:127], v[172:175]
  s_waitcnt vmcnt(4)
  s_barrier
  s_mul_i32 s77, s76, 176128
  s_lshl_b32 s78, s76, 7
  s_add_u32 s77, s77, s74
  s_add_u32 s78, s78, s73
  s_add_u32 s76, s76, 1
  s_and_b32 s76, s76, 7
  s_waitcnt vmcnt(4)
  v_cmp_ne_u64 vcc, v[246:247], v[56:57]
  s_cbranch_vccnz F_slow_13
F_back_14:
  s_waitcnt lgkmcnt(0)
  v_mfma_f32_16x16x32_bf16 v[140:143], v[176:179], v[200:203], v[140:143]
  ds_read_b128 v[208:211], v75 offset:0
  ds_read_b64_tr_b16 v[188:189], v71 offset:0
  s_add_u32 m0, s75, 122880
  s_nop 0
  buffer_load_dwordx4 v53, s[36:39], s78 offen lds
  v_mfma_f32_16x16x32_bf16 v[144:147], v[176:179], v[204:207], v[144:147]
  ds_read_b64_tr_b16 v[190:191], v71 offset:512
  ds_read_b128 v[212:215], v75 offset:2048
  v_mfma_f32_16x16x32_bf16 v[148:151], v[180:183], v[200:203], v[148:151]
  ds_read_b64_tr_b16 v[192:193], v72 offset:0
  ds_read_b64_tr_b16 v[194:195], v72 offset:512
  s_add_u32 m0, s75, 98304
  s_nop 0
  buffer_load_dwordx4 v51, s[40:43], s77 offen lds
  v_mfma_f32_16x16x32_bf16 v[152:155], v[180:183], v[204:207], v[152:155]
  ds_read_b64_tr_b16 v[196:197], v73 offset:0
  ds_read_b64_tr_b16 v[198:199], v73 offset:512
  v_mfma_f32_16x16x32_bf16 v[156:159], v[184:187], v[200:203], v[156:159]
  s_add_u32 m0, s75, 106496
  s_add_u32 s77, s77, 128
  buffer_load_dwordx4 v51, s[40:43], s77 offen lds
  ds_read_b128 v[216:219], v106
  v_mfma_f32_16x16x32_bf16 v[160:163], v[184:187], v[204:207], v[160:163]
  v_mov_b32 v246, v245
  v_mfma_f32_16x16x32_bf16 v[164:167], v[176:179], v[124:127], v[164:167]
  s_add_u32 m0, s75, 114688
  s_add_u32 s77, s77, 128
  buffer_load_dwordx4 v52, s[40:43], s77 offen lds
  buffer_load_dwordx2 v[128:129], v109, s[52:55], 0 offen sc1
  v_mfma_f32_16x16x32_bf16 v[168:171], v[180:183], v[124:127], v[168:171]
  v_mfma_f32_16x16x32_bf16 v[172:175], v[184:187], v[124:127], v[172:175]
  buffer_load_dwordx2 v[130:131], v109, s[52:55], 0 offen offset:256 sc1
  s_waitcnt lgkmcnt(0)
  v_mfma_f32_16x16x32_bf16 v[140:143], v[188:191], v[208:211], v[140:143]
  ds_read_b128 v[200:203], v74 offset:32768
  ds_read_b64_tr_b16 v[176:177], v68 offset:32768
  v_mfma_f32_16x16x32_bf16 v[144:147], v[188:191], v[212:215], v[144:147]
  ds_read_b64_tr_b16 v[178:179], v68 offset:33280
  ds_read_b128 v[204:207], v74 offset:34816
  v_lshlrev_b32 v236, 16, v216
  v_and_b32 v237, 0xffff0000, v216
  v_lshlrev_b32 v238, 16, v217
  v_and_b32 v239, 0xffff0000, v217
  v_mfma_f32_16x16x32_bf16 v[148:151], v[192:195], v[208:211], v[148:151]
  ds_read_b64_tr_b16 v[180:181], v69 offset:32768
  ds_read_b64_tr_b16 v[182:183], v69 offset:33280
  v_mfma_f32_16x16x32_bf16 v[152:155], v[192:195], v[212:215], v[152:155]
  ds_read_b64_tr_b16 v[184:185], v70 offset:32768
  ds_read_b64_tr_b16 v[186:187], v70 offset:33280
  v_lshlrev_b32 v240, 16, v218
  v_and_b32 v241, 0xffff0000, v218
  v_lshlrev_b32 v242, 16, v219
  v_and_b32 v243, 0xffff0000, v219
  v_mfma_f32_16x16x32_bf16 v[156:159], v[196:199], v[208:211], v[156:159]
  v_pk_fma_f32 v[236:237], v[236:237], v[244:245], v[246:247] op_sel:[0,0,0] op_sel_hi:[1,0,0]
  v_pk_fma_f32 v[238:239], v[238:239], v[244:245], v[246:247] op_sel:[0,0,0] op_sel_hi:[1,0,0]
  v_mfma_f32_16x16x32_bf16 v[160:163], v[196:199], v[212:215], v[160:163]
  v_pk_fma_f32 v[240:241], v[240:241], v[244:245], v[246:247] op_sel:[0,0,0] op_sel_hi:[1,0,0]
  v_pk_fma_f32 v[242:243], v[242:243], v[244:245], v[246:247] op_sel:[0,0,0] op_sel_hi:[1,0,0]
  v_mfma_f32_16x16x32_bf16 v[164:167], v[188:191], v[124:127], v[164:167]
  v_mfma_f32_16x16x32_bf16 v[168:171], v[192:195], v[124:127], v[168:171]
  v_mfma_f32_16x16x32_bf16 v[172:175], v[196:199], v[124:127], v[172:175]
  s_waitcnt vmcnt(6)
  s_barrier
  s_waitcnt lgkmcnt(0)
  v_mfma_f32_16x16x32_bf16 v[140:143], v[176:179], v[200:203], v[140:143]
  ds_read_b128 v[208:211], v75 offset:32768
  ds_read_b64_tr_b16 v[188:189], v71 offset:32768
  v_cvt_pk_bf16_f32 v216, v236, v237
  v_cvt_pk_bf16_f32 v217, v238, v239
  v_cvt_pk_bf16_f32 v218, v240, v241
  v_cvt_pk_bf16_f32 v219, v242, v243
  v_mfma_f32_16x16x32_bf16 v[144:147], v[176:179], v[204:207], v[144:147]
  ds_read_b64_tr_b16 v[190:191], v71 offset:33280
  ds_read_b128 v[212:215], v75 offset:34816
  v_mfma_f32_16x16x32_bf16 v[148:151], v[180:183], v[200:203], v[148:151]
  ds_read_b64_tr_b16 v[192:193], v72 offset:32768
  ds_read_b64_tr_b16 v[194:195], v72 offset:33280
  v_permlane32_swap_b32 v216, v218
  v_permlane32_swap_b32 v217, v219
  v_mfma_f32_16x16x32_bf16 v[152:155], v[180:183], v[204:207], v[152:155]
  ds_read_b64_tr_b16 v[196:197], v73 offset:32768
  ds_read_b64_tr_b16 v[198:199], v73 offset:33280
  v_mfma_f32_16x16x32_bf16 v[156:159], v[184:187], v[200:203], v[156:159]
  v_permlane16_swap_b32 v216, v217
  v_permlane16_swap_b32 v218, v219
  v_mfma_f32_16x16x32_bf16 v[160:163], v[184:187], v[204:207], v[160:163]
  v_mfma_f32_16x16x32_bf16 v[164:167], v[176:179], v[124:127], v[164:167]
  v_perm_b32 v236, v217, v216, s14
  v_perm_b32 v237, v219, v218, s14
  v_perm_b32 v240, v217, v216, s15
  v_perm_b32 v241, v219, v218, s15
  v_mfma_f32_16x16x32_bf16 v[168:171], v[180:183], v[124:127], v[168:171]
  v_mfma_f32_16x16x32_bf16 v[172:175], v[184:187], v[124:127], v[172:175]
  v_mov_b32 v238, v56
  v_mov_b32 v239, v57
  v_mov_b32 v242, v56
  v_mov_b32 v243, v57
  s_waitcnt lgkmcnt(0)
  v_mfma_f32_16x16x32_bf16 v[140:143], v[188:191], v[208:211], v[140:143]
  ds_read_b128 v[200:203], v254 offset:0
  ds_read_b64_tr_b16 v[176:177], v248 offset:0
  v_mfma_f32_16x16x32_bf16 v[144:147], v[188:191], v[212:215], v[144:147]
  ds_read_b64_tr_b16 v[178:179], v248 offset:512
  ds_read_b128 v[204:207], v254 offset:2048
  v_mfma_f32_16x16x32_bf16 v[148:151], v[192:195], v[208:211], v[148:151]
  ds_read_b64_tr_b16 v[180:181], v249 offset:0
  ds_read_b64_tr_b16 v[182:183], v249 offset:512
  v_mfma_f32_16x16x32_bf16 v[152:155], v[192:195], v[212:215], v[152:155]
  ds_read_b64_tr_b16 v[184:185], v250 offset:0
  ds_read_b64_tr_b16 v[186:187], v250 offset:512
  v_mfma_f32_16x16x32_bf16 v[156:159], v[196:199], v[208:211], v[156:159]
  v_mfma_f32_16x16x32_bf16 v[160:163], v[196:199], v[212:215], v[160:163]
  v_mfma_f32_16x16x32_bf16 v[164:167], v[188:191], v[124:127], v[164:167]
  v_mfma_f32_16x16x32_bf16 v[168:171], v[192:195], v[124:127], v[168:171]
  v_mfma_f32_16x16x32_bf16 v[172:175], v[196:199], v[124:127], v[172:175]
  s_waitcnt vmcnt(2)
  s_barrier
  s_waitcnt lgkmcnt(0)
  v_mfma_f32_16x16x32_bf16 v[140:143], v[176:179], v[200:203], v[140:143]
  ds_read_b128 v[208:211], v255 offset:0
  ds_read_b64_tr_b16 v[188:189], v251 offset:0
  buffer_store_dwordx4 v[236:239], v107, s[52:55], 0 offen sc1
  v_mfma_f32_16x16x32_bf16 v[144:147], v[176:179], v[204:207], v[144:147]
  ds_read_b64_tr_b16 v[190:191], v251 offset:512
  ds_read_b128 v[212:215], v255 offset:2048
  v_mfma_f32_16x16x32_bf16 v[148:151], v[180:183], v[200:203], v[148:151]
  ds_read_b64_tr_b16 v[192:193], v252 offset:0
  ds_read_b64_tr_b16 v[194:195], v252 offset:512
  s_movk_i32 s70, 0x2000
  buffer_store_dwordx4 v[240:243], v107, s[52:55], s70 offen sc1
  v_mfma_f32_16x16x32_bf16 v[152:155], v[180:183], v[204:207], v[152:155]
  ds_read_b64_tr_b16 v[196:197], v253 offset:0
  ds_read_b64_tr_b16 v[198:199], v253 offset:512
  v_mfma_f32_16x16x32_bf16 v[156:159], v[184:187], v[200:203], v[156:159]
  v_mfma_f32_16x16x32_bf16 v[160:163], v[184:187], v[204:207], v[160:163]
  v_mfma_f32_16x16x32_bf16 v[164:167], v[176:179], v[124:127], v[164:167]
  v_mfma_f32_16x16x32_bf16 v[168:171], v[180:183], v[124:127], v[168:171]
  v_mfma_f32_16x16x32_bf16 v[172:175], v[184:187], v[124:127], v[172:175]
  s_waitcnt lgkmcnt(0)
  v_mfma_f32_16x16x32_bf16 v[140:143], v[188:191], v[208:211], v[140:143]
  ds_read_b128 v[200:203], v254 offset:32768
  ds_read_b64_tr_b16 v[176:177], v248 offset:32768
  v_mfma_f32_16x16x32_bf16 v[144:147], v[188:191], v[212:215], v[144:147]
  ds_read_b64_tr_b16 v[178:179], v248 offset:33280
  ds_read_b128 v[204:207], v254 offset:34816
  v_mfma_f32_16x16x32_bf16 v[148:151], v[192:195], v[208:211], v[148:151]
  ds_read_b64_tr_b16 v[180:181], v249 offset:32768
  ds_read_b64_tr_b16 v[182:183], v249 offset:33280
  v_mfma_f32_16x16x32_bf16 v[152:155], v[192:195], v[212:215], v[152:155]
  ds_read_b64_tr_b16 v[184:185], v250 offset:32768
  ds_read_b64_tr_b16 v[186:187], v250 offset:33280
  v_mfma_f32_16x16x32_bf16 v[156:159], v[196:199], v[208:211], v[156:159]
  v_mfma_f32_16x16x32_bf16 v[160:163], v[196:199], v[212:215], v[160:163]
  v_mfma_f32_16x16x32_bf16 v[164:167], v[188:191], v[124:127], v[164:167]
  v_mfma_f32_16x16x32_bf16 v[168:171], v[192:195], v[124:127], v[168:171]
  v_mfma_f32_16x16x32_bf16 v[172:175], v[196:199], v[124:127], v[172:175]
  s_waitcnt lgkmcnt(0)
  v_mfma_f32_16x16x32_bf16 v[140:143], v[176:179], v[200:203], v[140:143]
  ds_read_b128 v[208:211], v255 offset:32768
  ds_read_b64_tr_b16 v[188:189], v251 offset:32768
  v_mfma_f32_16x16x32_bf16 v[144:147], v[176:179], v[204:207], v[144:147]
  ds_read_b64_tr_b16 v[190:191], v251 offset:33280
  ds_read_b128 v[212:215], v255 offset:34816
  v_mfma_f32_16x16x32_bf16 v[148:151], v[180:183], v[200:203], v[148:151]
  ds_read_b64_tr_b16 v[192:193], v252 offset:32768
  ds_read_b64_tr_b16 v[194:195], v252 offset:33280
  v_mfma_f32_16x16x32_bf16 v[152:155], v[180:183], v[204:207], v[152:155]
  ds_read_b64_tr_b16 v[196:197], v253 offset:32768
  ds_read_b64_tr_b16 v[198:199], v253 offset:33280
  v_mfma_f32_16x16x32_bf16 v[156:159], v[184:187], v[200:203], v[156:159]
  v_mfma_f32_16x16x32_bf16 v[160:163], v[184:187], v[204:207], v[160:163]
  v_mfma_f32_16x16x32_bf16 v[164:167], v[176:179], v[124:127], v[164:167]
  s_lshl_b32 s71, s61, 3
  v_min_u32 v60, 7, v36
  s_lshl_b32 s70, s71, 7
  s_add_u32 s70, s70, 12615680
  v_lshl_add_u32 v60, v60, 7, s70
  v_mfma_f32_16x16x32_bf16 v[168:171], v[180:183], v[124:127], v[168:171]
  v_mfma_f32_16x16x32_bf16 v[172:175], v[184:187], v[124:127], v[172:175]
  s_waitcnt lgkmcnt(0)
  v_mfma_f32_16x16x32_bf16 v[140:143], v[188:191], v[208:211], v[140:143]
  v_mfma_f32_16x16x32_bf16 v[144:147], v[188:191], v[212:215], v[144:147]
  v_mfma_f32_16x16x32_bf16 v[148:151], v[192:195], v[208:211], v[148:151]
  v_mfma_f32_16x16x32_bf16 v[152:155], v[192:195], v[212:215], v[152:155]
  v_mfma_f32_16x16x32_bf16 v[156:159], v[196:199], v[208:211], v[156:159]
  v_mfma_f32_16x16x32_bf16 v[160:163], v[196:199], v[212:215], v[160:163]
  v_mfma_f32_16x16x32_bf16 v[164:167], v[188:191], v[124:127], v[164:167]
  v_mfma_f32_16x16x32_bf16 v[168:171], v[192:195], v[124:127], v[168:171]
  v_mfma_f32_16x16x32_bf16 v[172:175], v[196:199], v[124:127], v[172:175]
  s_waitcnt lgkmcnt(0)
  s_mov_b64 exec, 1
  ds_add_u32 v46, v48 offset:0
  s_mov_b64 exec, -1
  s_nop 7
  s_mov_b32 exec_lo, 0x00010001
  s_mov_b32 exec_hi, 0x00010001
  ds_write_b128 v104, v[164:167] offset:0
  ds_write_b128 v104, v[168:171] offset:64
  ds_write_b128 v104, v[172:175] offset:128
  s_mov_b64 exec, -1
  v_mov_b32 v42, 1
  s_waitcnt lgkmcnt(0)
  ds_write_b32 v105, v42
  s_branch F_g1j_12
F_g1v1_11:
  s_waitcnt lgkmcnt(0)
  v_mfma_f32_16x16x32_bf16 v[140:143], v[176:179], v[200:203], 0
  ds_read_b128 v[208:211], v75 offset:0
  ds_read_b64_tr_b16 v[188:189], v71 offset:0
  v_mfma_f32_16x16x32_bf16 v[144:147], v[176:179], v[204:207], 0
  ds_read_b64_tr_b16 v[190:191], v71 offset:512
  ds_read_b128 v[212:215], v75 offset:2048
  s_mul_i32 s77, s76, 176128
  s_lshl_b32 s78, s76, 7
  s_add_u32 s77, s77, s74
  s_add_u32 s78, s78, s73
  s_add_u32 s76, s76, 1
  s_and_b32 s76, s76, 7
  s_add_u32 m0, s75, 90112
  s_nop 0
  buffer_load_dwordx4 v53, s[36:39], s78 offen lds
  ds_read_b64_tr_b16 v[192:193], v72 offset:0
  ds_read_b64_tr_b16 v[194:195], v72 offset:512
  v_mfma_f32_16x16x32_bf16 v[148:151], v[180:183], v[200:203], 0
  ds_read_b64_tr_b16 v[196:197], v73 offset:0
  ds_read_b64_tr_b16 v[198:199], v73 offset:512
  s_add_u32 m0, s75, 65536
  s_nop 0
  buffer_load_dwordx4 v51, s[40:43], s77 offen lds
  v_mfma_f32_16x16x32_bf16 v[152:155], v[180:183], v[204:207], 0
  s_add_u32 m0, s75, 73728
  s_add_u32 s77, s77, 128
  buffer_load_dwordx4 v51, s[40:43], s77 offen lds
  v_mfma_f32_16x16x32_bf16 v[156:159], v[184:187], v[200:203], 0
  v_mfma_f32_16x16x32_bf16 v[160:163], v[184:187], v[204:207], 0
  s_add_u32 m0, s75, 81920
  s_add_u32 s77, s77, 128
  buffer_load_dwordx4 v52, s[40:43], s77 offen lds
  s_lshl_b32 s70, s62, 7
  s_add_u32 s70, s70, s73
  s_add_u32 m0, s75, 131072
  s_nop 0
  buffer_load_dwordx4 v53, s[36:39], s70 offen lds
  s_waitcnt lgkmcnt(0)
  s_waitcnt vmcnt(6)
  s_barrier
  v_mfma_f32_16x16x32_bf16 v[140:143], v[188:191], v[208:211], v[140:143]
  ds_read_b128 v[200:203], v74 offset:32768
  ds_read_b64_tr_b16 v[176:177], v68 offset:32768
  global_load_dwordx2 v[76:77], v101, s[22:23]
  global_load_dwordx2 v[78:79], v102, s[22:23]
  global_load_dwordx2 v[80:81], v103, s[22:23]
  v_mfma_f32_16x16x32_bf16 v[144:147], v[188:191], v[212:215], v[144:147]
  ds_read_b64_tr_b16 v[178:179], v68 offset:33280
  ds_read_b128 v[204:207], v74 offset:34816
  v_mfma_f32_16x16x32_bf16 v[148:151], v[192:195], v[208:211], v[148:151]
  ds_read_b64_tr_b16 v[180:181], v69 offset:32768
  ds_read_b64_tr_b16 v[182:183], v69 offset:33280
  s_mul_i32 s77, s76, 176128
  s_lshl_b32 s78, s76, 7
  s_add_u32 s77, s77, s74
  s_add_u32 s78, s78, s73
  s_add_u32 s76, s76, 1
  s_and_b32 s76, s76, 7
  s_add_u32 m0, s75, 122880
  s_nop 0
  buffer_load_dwordx4 v53, s[36:39], s78 offen lds
  v_mfma_f32_16x16x32_bf16 v[152:155], v[192:195], v[212:215], v[152:155]
  ds_read_b64_tr_b16 v[184:185], v70 offset:32768
  ds_read_b64_tr_b16 v[186:187], v70 offset:33280
  s_add_u32 m0, s75, 98304
  s_nop 0
  buffer_load_dwordx4 v51, s[40:43], s77 offen lds
  v_mfma_f32_16x16x32_bf16 v[156:159], v[196:199], v[208:211], v[156:159]
  s_add_u32 m0, s75, 106496
  s_add_u32 s77, s77, 128
  buffer_load_dwordx4 v51, s[40:43], s77 offen lds
  v_mfma_f32_16x16x32_bf16 v[160:163], v[196:199], v[212:215], v[160:163]
  s_add_u32 m0, s75, 114688
  s_add_u32 s77, s77, 128
  buffer_load_dwordx4 v52, s[40:43], s77 offen lds
  s_waitcnt vmcnt(8)
  s_barrier
  s_mul_i32 s77, s76, 176128
  s_lshl_b32 s78, s76, 7
  s_add_u32 s77, s77, s74
  s_add_u32 s78, s78, s73
  s_add_u32 s76, s76, 1
  s_and_b32 s76, s76, 7
  s_waitcnt lgkmcnt(0)
  v_mfma_f32_16x16x32_bf16 v[140:143], v[176:179], v[200:203], v[140:143]
  ds_read_b128 v[208:211], v75 offset:32768
  ds_read_b64_tr_b16 v[188:189], v71 offset:32768
  v_mfma_f32_16x16x32_bf16 v[144:147], v[176:179], v[204:207], v[144:147]
  ds_read_b64_tr_b16 v[190:191], v71 offset:33280
  ds_read_b128 v[212:215], v75 offset:34816
  s_add_u32 m0, s75, 24576
  s_nop 0
  buffer_load_dwordx4 v53, s[36:39], s78 offen lds
  ds_read_b64_tr_b16 v[192:193], v72 offset:32768
  ds_read_b64_tr_b16 v[194:195], v72 offset:33280
  v_mfma_f32_16x16x32_bf16 v[148:151], v[180:183], v[200:203], v[148:151]
  ds_read_b64_tr_b16 v[196:197], v73 offset:32768
  ds_read_b64_tr_b16 v[198:199], v73 offset:33280
  s_add_u32 m0, s75, 0
  s_nop 0
  buffer_load_dwordx4 v51, s[40:43], s77 offen lds
  v_mfma_f32_16x16x32_bf16 v[152:155], v[180:183], v[204:207], v[152:155]
  s_add_u32 m0, s75, 8192
  s_add_u32 s77, s77, 128
  buffer_load_dwordx4 v51, s[40:43], s77 offen lds
  v_mfma_f32_16x16x32_bf16 v[156:159], v[184:187], v[200:203], v[156:159]
  v_mfma_f32_16x16x32_bf16 v[160:163], v[184:187], v[204:207], v[160:163]
  s_add_u32 m0, s75, 16384
  s_add_u32 s77, s77, 128
  buffer_load_dwordx4 v52, s[40:43], s77 offen lds
  s_waitcnt lgkmcnt(0)
  v_mfma_f32_16x16x32_bf16 v[140:143], v[188:191], v[208:211], v[140:143]
  ds_read_b128 v[200:203], v254 offset:0
  ds_read_b64_tr_b16 v[176:177], v248 offset:0
  v_mfma_f32_16x16x32_bf16 v[144:147], v[188:191], v[212:215], v[144:147]
  ds_read_b64_tr_b16 v[178:179], v248 offset:512
  ds_read_b128 v[204:207], v254 offset:2048
  v_mfma_f32_16x16x32_bf16 v[148:151], v[192:195], v[208:211], v[148:151]
  ds_read_b64_tr_b16 v[180:181], v249 offset:0
  ds_read_b64_tr_b16 v[182:183], v249 offset:512
  v_mfma_f32_16x16x32_bf16 v[152:155], v[192:195], v[212:215], v[152:155]
  ds_read_b64_tr_b16 v[184:185], v250 offset:0
  ds_read_b64_tr_b16 v[186:187], v250 offset:512
  v_mfma_f32_16x16x32_bf16 v[156:159], v[196:199], v[208:211], v[156:159]
  v_mfma_f32_16x16x32_bf16 v[160:163], v[196:199], v[212:215], v[160:163]
  buffer_load_dwordx4 v[244:247], v110, s[52:55], 0 offen sc1
  s_waitcnt vmcnt(5)
  s_barrier
  s_mul_i32 s77, s76, 176128
  s_lshl_b32 s78, s76, 7
  s_add_u32 s77, s77, s74
  s_add_u32 s78, s78, s73
  s_add_u32 s76, s76, 1
  s_and_b32 s76, s76, 7
  s_waitcnt lgkmcnt(0)
  v_mfma_f32_16x16x32_bf16 v[140:143], v[176:179], v[200:203], v[140:143]
  ds_read_b128 v[208:211], v255 offset:0
  ds_read_b64_tr_b16 v[188:189], v251 offset:0
  v_mfma_f32_16x16x32_bf16 v[144:147], v[176:179], v[204:207], v[144:147]
  ds_read_b64_tr_b16 v[190:191], v251 offset:512
  ds_read_b128 v[212:215], v255 offset:2048
  s_add_u32 m0, s75, 57344
  s_nop 0
  buffer_load_dwordx4 v53, s[36:39], s78 offen lds
  ds_read_b64_tr_b16 v[192:193], v252 offset:0
  ds_read_b64_tr_b16 v[194:195], v252 offset:512
  v_mfma_f32_16x16x32_bf16 v[148:151], v[180:183], v[200:203], v[148:151]
  ds_read_b64_tr_b16 v[196:197], v253 offset:0
  ds_read_b64_tr_b16 v[198:199], v253 offset:512
  s_add_u32 m0, s75, 32768
  s_nop 0
  buffer_load_dwordx4 v51, s[40:43], s77 offen lds
  v_mfma_f32_16x16x32_bf16 v[152:155], v[180:183], v[204:207], v[152:155]
  s_add_u32 m0, s75, 40960
  s_add_u32 s77, s77, 128
  buffer_load_dwordx4 v51, s[40:43], s77 offen lds
  v_mfma_f32_16x16x32_bf16 v[156:159], v[184:187], v[200:203], v[156:159]
  v_mfma_f32_16x16x32_bf16 v[160:163], v[184:187], v[204:207], v[160:163]
  s_add_u32 m0, s75, 49152
  s_add_u32 s77, s77, 128
  buffer_load_dwordx4 v52, s[40:43], s77 offen lds
  s_waitcnt lgkmcnt(0)
  v_mfma_f32_16x16x32_bf16 v[140:143], v[188:191], v[208:211], v[140:143]
  ds_read_b128 v[200:203], v254 offset:32768
  ds_read_b64_tr_b16 v[176:177], v248 offset:32768
  v_mfma_f32_16x16x32_bf16 v[144:147], v[188:191], v[212:215], v[144:147]
  ds_read_b64_tr_b16 v[178:179], v248 offset:33280
  ds_read_b128 v[204:207], v254 offset:34816
  v_mfma_f32_16x16x32_bf16 v[148:151], v[192:195], v[208:211], v[148:151]
  ds_read_b64_tr_b16 v[180:181], v249 offset:32768
  ds_read_b64_tr_b16 v[182:183], v249 offset:33280
  v_mfma_f32_16x16x32_bf16 v[152:155], v[192:195], v[212:215], v[152:155]
  ds_read_b64_tr_b16 v[184:185], v250 offset:32768
  ds_read_b64_tr_b16 v[186:187], v250 offset:33280
  v_mfma_f32_16x16x32_bf16 v[156:159], v[196:199], v[208:211], v[156:159]
  v_mfma_f32_16x16x32_bf16 v[160:163], v[196:199], v[212:215], v[160:163]
  s_waitcnt vmcnt(5)
  s_barrier
  s_mul_i32 s77, s76, 176128
  s_lshl_b32 s78, s76, 7
  s_add_u32 s77, s77, s74
  s_add_u32 s78, s78, s73
  s_add_u32 s76, s76, 1
  s_and_b32 s76, s76, 7
  s_waitcnt lgkmcnt(0)
  v_mfma_f32_16x16x32_bf16 v[140:143], v[176:179], v[200:203], v[140:143]
  ds_read_b128 v[208:211], v255 offset:32768
  ds_read_b64_tr_b16 v[188:189], v251 offset:32768
  v_mfma_f32_16x16x32_bf16 v[144:147], v[176:179], v[204:207], v[144:147]
  ds_read_b64_tr_b16 v[190:191], v251 offset:33280
  ds_read_b128 v[212:215], v255 offset:34816
  s_add_u32 m0, s75, 90112
  s_nop 0
  buffer_load_dwordx4 v53, s[36:39], s78 offen lds
  ds_read_b64_tr_b16 v[192:193], v252 offset:32768
  ds_read_b64_tr_b16 v[194:195], v252 offset:33280
  v_mfma_f32_16x16x32_bf16 v[148:151], v[180:183], v[200:203], v[148:151]
  ds_read_b64_tr_b16 v[196:197], v253 offset:32768
  ds_read_b64_tr_b16 v[198:199], v253 offset:33280
  s_add_u32 m0, s75, 65536
  s_nop 0
  buffer_load_dwordx4 v51, s[40:43], s77 offen lds
  v_mfma_f32_16x16x32_bf16 v[152:155], v[180:183], v[204:207], v[152:155]
  s_add_u32 m0, s75, 73728
  s_add_u32 s77, s77, 128
  buffer_load_dwordx4 v51, s[40:43], s77 offen lds
  v_mfma_f32_16x16x32_bf16 v[156:159], v[184:187], v[200:203], v[156:159]
  v_mfma_f32_16x16x32_bf16 v[160:163], v[184:187], v[204:207], v[160:163]
  s_add_u32 m0, s75, 81920
  s_add_u32 s77, s77, 128
  buffer_load_dwordx4 v52, s[40:43], s77 offen lds
  s_waitcnt lgkmcnt(0)
  v_mfma_f32_16x16x32_bf16 v[140:143], v[188:191], v[208:211], v[140:143]
  ds_read_b128 v[200:203], v74 offset:0
  ds_read_b64_tr_b16 v[176:177], v68 offset:0
  v_mfma_f32_16x16x32_bf16 v[144:147], v[188:191], v[212:215], v[144:147]
  ds_read_b64_tr_b16 v[178:179], v68 offset:512
  ds_read_b128 v[204:207], v74 offset:2048
  v_mfma_f32_16x16x32_bf16 v[148:151], v[192:195], v[208:211], v[148:151]
  ds_read_b64_tr_b16 v[180:181], v69 offset:0
  ds_read_b64_tr_b16 v[182:183], v69 offset:512
  v_mfma_f32_16x16x32_bf16 v[152:155], v[192:195], v[212:215], v[152:155]
  ds_read_b64_tr_b16 v[184:185], v70 offset:0
  ds_read_b64_tr_b16 v[186:187], v70 offset:512
  v_mfma_f32_16x16x32_bf16 v[156:159], v[196:199], v[208:211], v[156:159]
  v_mfma_f32_16x16x32_bf16 v[160:163], v[196:199], v[212:215], v[160:163]
  s_waitcnt vmcnt(4)
  s_barrier
  s_mul_i32 s77, s76, 176128
  s_lshl_b32 s78, s76, 7
  s_add_u32 s77, s77, s74
  s_add_u32 s78, s78, s73
  s_add_u32 s76, s76, 1
  s_and_b32 s76, s76, 7
  s_waitcnt vmcnt(4)
  v_cmp_ne_u64 vcc, v[246:247], v[56:57]
  s_cbranch_vccnz F_slow_15
F_back_16:
  s_waitcnt lgkmcnt(0)
  v_mfma_f32_16x16x32_bf16 v[140:143], v[176:179], v[200:203], v[140:143]
  ds_read_b128 v[208:211], v75 offset:0
  ds_read_b64_tr_b16 v[188:189], v71 offset:0
  v_mfma_f32_16x16x32_bf16 v[144:147], v[176:179], v[204:207], v[144:147]
  ds_read_b64_tr_b16 v[190:191], v71 offset:512
  ds_read_b128 v[212:215], v75 offset:2048
  s_add_u32 m0, s75, 122880
  s_nop 0
  buffer_load_dwordx4 v53, s[36:39], s78 offen lds
  ds_read_b64_tr_b16 v[192:193], v72 offset:0
  ds_read_b64_tr_b16 v[194:195], v72 offset:512
  v_mfma_f32_16x16x32_bf16 v[148:151], v[180:183], v[200:203], v[148:151]
  ds_read_b64_tr_b16 v[196:197], v73 offset:0
  ds_read_b64_tr_b16 v[198:199], v73 offset:512
  s_add_u32 m0, s75, 98304
  s_nop 0
  buffer_load_dwordx4 v51, s[40:43], s77 offen lds
  v_mfma_f32_16x16x32_bf16 v[152:155], v[180:183], v[204:207], v[152:155]
  ds_read_b128 v[216:219], v106
  s_add_u32 m0, s75, 106496
  s_add_u32 s77, s77, 128
  buffer_load_dwordx4 v51, s[40:43], s77 offen lds
  v_mov_b32 v246, v245
  v_mfma_f32_16x16x32_bf16 v[156:159], v[184:187], v[200:203], v[156:159]
  buffer_load_dwordx2 v[128:129], v109, s[52:55], 0 offen sc1
  v_mfma_f32_16x16x32_bf16 v[160:163], v[184:187], v[204:207], v[160:163]
  s_add_u32 m0, s75, 114688
  s_add_u32 s77, s77, 128
  buffer_load_dwordx4 v52, s[40:43], s77 offen lds
  buffer_load_dwordx2 v[130:131], v109, s[52:55], 0 offen offset:256 sc1
  s_waitcnt lgkmcnt(0)
  v_mfma_f32_16x16x32_bf16 v[140:143], v[188:191], v[208:211], v[140:143]
  ds_read_b128 v[200:203], v74 offset:32768
  ds_read_b64_tr_b16 v[176:177], v68 offset:32768
  v_mfma_f32_16x16x32_bf16 v[144:147], v[188:191], v[212:215], v[144:147]
  ds_read_b64_tr_b16 v[178:179], v68 offset:33280
  ds_read_b128 v[204:207], v74 offset:34816
  v_lshlrev_b32 v236, 16, v216
  v_and_b32 v237, 0xffff0000, v216
  v_lshlrev_b32 v238, 16, v217
  v_and_b32 v239, 0xffff0000, v217
  v_mfma_f32_16x16x32_bf16 v[148:151], v[192:195], v[208:211], v[148:151]
  ds_read_b64_tr_b16 v[180:181], v69 offset:32768
  ds_read_b64_tr_b16 v[182:183], v69 offset:33280
  v_mfma_f32_16x16x32_bf16 v[152:155], v[192:195], v[212:215], v[152:155]
  ds_read_b64_tr_b16 v[184:185], v70 offset:32768
  ds_read_b64_tr_b16 v[186:187], v70 offset:33280
  v_lshlrev_b32 v240, 16, v218
  v_and_b32 v241, 0xffff0000, v218
  v_lshlrev_b32 v242, 16, v219
  v_and_b32 v243, 0xffff0000, v219
  v_mfma_f32_16x16x32_bf16 v[156:159], v[196:199], v[208:211], v[156:159]
  v_pk_fma_f32 v[236:237], v[236:237], v[244:245], v[246:247] op_sel:[0,0,0] op_sel_hi:[1,0,0]
  v_pk_fma_f32 v[238:239], v[238:239], v[244:245], v[246:247] op_sel:[0,0,0] op_sel_hi:[1,0,0]
  v_mfma_f32_16x16x32_bf16 v[160:163], v[196:199], v[212:215], v[160:163]
  v_pk_fma_f32 v[240:241], v[240:241], v[244:245], v[246:247] op_sel:[0,0,0] op_sel_hi:[1,0,0]
  v_pk_fma_f32 v[242:243], v[242:243], v[244:245], v[246:247] op_sel:[0,0,0] op_sel_hi:[1,0,0]
  s_waitcnt vmcnt(6)
  s_barrier
  s_waitcnt lgkmcnt(0)
  v_mfma_f32_16x16x32_bf16 v[140:143], v[176:179], v[200:203], v[140:143]
  ds_read_b128 v[208:211], v75 offset:32768
  ds_read_b64_tr_b16 v[188:189], v71 offset:32768
  v_cvt_pk_bf16_f32 v216, v236, v237
  v_cvt_pk_bf16_f32 v217, v238, v239
  v_cvt_pk_bf16_f32 v218, v240, v241
  v_cvt_pk_bf16_f32 v219, v242, v243
  v_mfma_f32_16x16x32_bf16 v[144:147], v[176:179], v[204:207], v[144:147]
  ds_read_b64_tr_b16 v[190:191], v71 offset:33280
  ds_read_b128 v[212:215], v75 offset:34816
  ds_read_b64_tr_b16 v[192:193], v72 offset:32768
  ds_read_b64_tr_b16 v[194:195], v72 offset:33280
  v_permlane32_swap_b32 v216, v218
  v_permlane32_swap_b32 v217, v219
  v_mfma_f32_16x16x32_bf16 v[148:151], v[180:183], v[200:203], v[148:151]
  ds_read_b64_tr_b16 v[196:197], v73 offset:32768
  ds_read_b64_tr_b16 v[198:199], v73 offset:33280
  v_mfma_f32_16x16x32_bf16 v[152:155], v[180:183], v[204:207], v[152:155]
  v_permlane16_swap_b32 v216, v217
  v_permlane16_swap_b32 v218, v219
  v_mfma_f32_16x16x32_bf16 v[156:159], v[184:187], v[200:203], v[156:159]
  v_perm_b32 v236, v217, v216, s14
  v_perm_b32 v237, v219, v218, s14
  v_perm_b32 v240, v217, v216, s15
  v_perm_b32 v241, v219, v218, s15
  v_mfma_f32_16x16x32_bf16 v[160:163], v[184:187], v[204:207], v[160:163]
  v_mov_b32 v238, v56
  v_mov_b32 v239, v57
  v_mov_b32 v242, v56
  v_mov_b32 v243, v57
  s_waitcnt lgkmcnt(0)
  v_mfma_f32_16x16x32_bf16 v[140:143], v[188:191], v[208:211], v[140:143]
  ds_read_b128 v[200:203], v254 offset:0
  ds_read_b64_tr_b16 v[176:177], v248 offset:0
  v_mfma_f32_16x16x32_bf16 v[144:147], v[188:191], v[212:215], v[144:147]
  ds_read_b64_tr_b16 v[178:179], v248 offset:512
  ds_read_b128 v[204:207], v254 offset:2048
  v_mfma_f32_16x16x32_bf16 v[148:151], v[192:195], v[208:211], v[148:151]
  ds_read_b64_tr_b16 v[180:181], v249 offset:0
  ds_read_b64_tr_b16 v[182:183], v249 offset:512
  v_mfma_f32_16x16x32_bf16 v[152:155], v[192:195], v[212:215], v[152:155]
  ds_read_b64_tr_b16 v[184:185], v250 offset:0
  ds_read_b64_tr_b16 v[186:187], v250 offset:512
  v_mfma_f32_16x16x32_bf16 v[156:159], v[196:199], v[208:211], v[156:159]
  v_mfma_f32_16x16x32_bf16 v[160:163], v[196:199], v[212:215], v[160:163]
  s_waitcnt vmcnt(1)
  s_barrier
  s_waitcnt lgkmcnt(0)
  v_mfma_f32_16x16x32_bf16 v[140:143], v[176:179], v[200:203], v[140:143]
  ds_read_b128 v[208:211], v255 offset:0
  ds_read_b64_tr_b16 v[188:189], v251 offset:0
  buffer_store_dwordx4 v[236:239], v107, s[52:55], 0 offen sc1
  v_mfma_f32_16x16x32_bf16 v[144:147], v[176:179], v[204:207], v[144:147]
  ds_read_b64_tr_b16 v[190:191], v251 offset:512
  ds_read_b128 v[212:215], v255 offset:2048
  ds_read_b64_tr_b16 v[192:193], v252 offset:0
  ds_read_b64_tr_b16 v[194:195], v252 offset:512
  s_movk_i32 s70, 0x2000
  buffer_store_dwordx4 v[240:243], v107, s[52:55], s70 offen sc1
  v_mfma_f32_16x16x32_bf16 v[148:151], v[180:183], v[200:203], v[148:151]
  ds_read_b64_tr_b16 v[196:197], v253 offset:0
  ds_read_b64_tr_b16 v[198:199], v253 offset:512
  v_mfma_f32_16x16x32_bf16 v[152:155], v[180:183], v[204:207], v[152:155]
  v_mfma_f32_16x16x32_bf16 v[156:159], v[184:187], v[200:203], v[156:159]
  v_mfma_f32_16x16x32_bf16 v[160:163], v[184:187], v[204:207], v[160:163]
  s_waitcnt lgkmcnt(0)
  v_mfma_f32_16x16x32_bf16 v[140:143], v[188:191], v[208:211], v[140:143]
  ds_read_b128 v[200:203], v254 offset:32768
  ds_read_b64_tr_b16 v[176:177], v248 offset:32768
  v_mfma_f32_16x16x32_bf16 v[144:147], v[188:191], v[212:215], v[144:147]
  ds_read_b64_tr_b16 v[178:179], v248 offset:33280
  ds_read_b128 v[204:207], v254 offset:34816
  v_mfma_f32_16x16x32_bf16 v[148:151], v[192:195], v[208:211], v[148:151]
  ds_read_b64_tr_b16 v[180:181], v249 offset:32768
  ds_read_b64_tr_b16 v[182:183], v249 offset:33280
  v_mfma_f32_16x16x32_bf16 v[152:155], v[192:195], v[212:215], v[152:155]
  ds_read_b64_tr_b16 v[184:185], v250 offset:32768
  ds_read_b64_tr_b16 v[186:187], v250 offset:33280
  v_mfma_f32_16x16x32_bf16 v[156:159], v[196:199], v[208:211], v[156:159]
  v_mfma_f32_16x16x32_bf16 v[160:163], v[196:199], v[212:215], v[160:163]
  s_waitcnt lgkmcnt(0)
  v_mfma_f32_16x16x32_bf16 v[140:143], v[176:179], v[200:203], v[140:143]
  ds_read_b128 v[208:211], v255 offset:32768
  ds_read_b64_tr_b16 v[188:189], v251 offset:32768
  v_mfma_f32_16x16x32_bf16 v[144:147], v[176:179], v[204:207], v[144:147]
  ds_read_b64_tr_b16 v[190:191], v251 offset:33280
  ds_read_b128 v[212:215], v255 offset:34816
  ds_read_b64_tr_b16 v[192:193], v252 offset:32768
  ds_read_b64_tr_b16 v[194:195], v252 offset:33280
  v_mfma_f32_16x16x32_bf16 v[148:151], v[180:183], v[200:203], v[148:151]
  ds_read_b64_tr_b16 v[196:197], v253 offset:32768
  ds_read_b64_tr_b16 v[198:199], v253 offset:33280
  v_mfma_f32_16x16x32_bf16 v[152:155], v[180:183], v[204:207], v[152:155]
  v_mfma_f32_16x16x32_bf16 v[156:159], v[184:187], v[200:203], v[156:159]
  s_lshl_b32 s71, s61, 3
  v_min_u32 v60, 7, v36
  s_lshl_b32 s70, s71, 7
  s_add_u32 s70, s70, 12615680
  v_lshl_add_u32 v60, v60, 7, s70
  v_mfma_f32_16x16x32_bf16 v[160:163], v[184:187], v[204:207], v[160:163]
  s_waitcnt lgkmcnt(0)
  v_mfma_f32_16x16x32_bf16 v[140:143], v[188:191], v[208:211], v[140:143]
  v_mfma_f32_16x16x32_bf16 v[144:147], v[188:191], v[212:215], v[144:147]
  v_mfma_f32_16x16x32_bf16 v[148:151], v[192:195], v[208:211], v[148:151]
  v_mfma_f32_16x16x32_bf16 v[152:155], v[192:195], v[212:215], v[152:155]
  v_mfma_f32_16x16x32_bf16 v[156:159], v[196:199], v[208:211], v[156:159]
  v_mfma_f32_16x16x32_bf16 v[160:163], v[196:199], v[212:215], v[160:163]
  s_waitcnt lgkmcnt(0)
  s_mov_b64 exec, 1
  ds_add_u32 v46, v48 offset:0
  s_mov_b64 exec, -1
  s_mov_b32 s72, 0
F_cs_17:
  ds_read_b32 v42, v105
  s_add_u32 s72, s72, 1
  s_waitcnt lgkmcnt(0)
  v_cmp_eq_u32 vcc, 1, v42
  s_cmp_lt_u32 s72, 262144
  s_cbranch_vccnz F_csok_18
  s_cbranch_scc1 F_cs_17
F_csok_18:
  ds_read_b128 v[164:167], v104 offset:0
  ds_read_b128 v[168:171], v104 offset:64
  ds_read_b128 v[172:175], v104 offset:128
F_g1j_12:
  s_waitcnt vmcnt(2)
  v_mov_b32 v220, 3216077336
  v_mov_b32 v222, 1069066811
  v_mov_b32 v216, 1060205080
  v_pk_mul_f32 v[128:129], v[128:129], v[222:223] op_sel_hi:[1,0]
  v_pk_mul_f32 v[130:131], v[130:131], v[222:223] op_sel_hi:[1,0]
  v_mov_b32 v244, v129
  v_mov_b32 v246, v131
  s_add_u32 s16, s63, s64
  s_waitcnt lgkmcnt(0)
  s_mov_b32 s71, 0
  v_lshlrev_b32 v176, 16, v76
  v_and_b32 v177, 0xffff0000, v76
  v_lshlrev_b32 v178, 16, v77
  v_and_b32 v179, 0xffff0000, v77
  v_pk_mul_f32 v[176:177], v[176:177], v[222:223] op_sel_hi:[1,0]
  v_pk_mul_f32 v[178:179], v[178:179], v[222:223] op_sel_hi:[1,0]
  v_pk_fma_f32 v[180:181], v[164:165], v[244:245], v[176:177] op_sel:[0,0,0] op_sel_hi:[1,0,1]
  v_pk_fma_f32 v[182:183], v[166:167], v[244:245], v[178:179] op_sel:[0,0,0] op_sel_hi:[1,0,1]
  v_pk_fma_f32 v[184:185], v[164:165], v[246:247], v[176:177] op_sel:[0,0,0] op_sel_hi:[1,0,1]
  v_pk_fma_f32 v[186:187], v[166:167], v[246:247], v[178:179] op_sel:[0,0,0] op_sel_hi:[1,0,1]
  ds_write_b32 v82, v4 offset:0
  ds_write_b32 v82, v5 offset:528
  v_pk_fma_f32 v[180:181], v[140:141], v[128:129], v[180:181] op_sel:[0,0,0] op_sel_hi:[1,0,1]
  v_pk_fma_f32 v[182:183], v[142:143], v[128:129], v[182:183] op_sel:[0,0,0] op_sel_hi:[1,0,1]
  v_pk_fma_f32 v[184:185], v[144:145], v[130:131], v[184:185] op_sel:[0,0,0] op_sel_hi:[1,0,1]
  v_pk_fma_f32 v[186:187], v[146:147], v[130:131], v[186:187] op_sel:[0,0,0] op_sel_hi:[1,0,1]
  v_exp_f32 v200, v180
  v_exp_f32 v201, v181
  ds_write_b32 v82, v6 offset:1056
  v_exp_f32 v202, v182
  v_exp_f32 v203, v183
  ds_write_b32 v82, v7 offset:1584
  v_exp_f32 v204, v184
  v_exp_f32 v205, v185
  ds_write_b32 v82, v8 offset:2112
  v_exp_f32 v206, v186
  v_exp_f32 v207, v187
  ds_write_b32 v82, v9 offset:2640
  v_pk_add_f32 v[228:229], v[200:201], 2.0 op_sel_hi:[1,0]
  v_pk_add_f32 v[230:231], v[202:203], 2.0 op_sel_hi:[1,0]
  v_pk_add_f32 v[232:233], v[204:205], 2.0 op_sel_hi:[1,0]
  v_pk_add_f32 v[234:235], v[206:207], 2.0 op_sel_hi:[1,0]
  v_pk_fma_f32 v[228:229], v[200:201], v[228:229], 2.0 op_sel_hi:[1,1,0]
  v_pk_fma_f32 v[230:231], v[202:203], v[230:231], 2.0 op_sel_hi:[1,1,0]
  v_pk_fma_f32 v[232:233], v[204:205], v[232:233], 2.0 op_sel_hi:[1,1,0]
  v_pk_fma_f32 v[234:235], v[206:207], v[234:235], 2.0 op_sel_hi:[1,1,0]
  v_rcp_f32 v228, v228
  v_rcp_f32 v229, v229
  ds_write_b32 v82, v10 offset:3168
  v_rcp_f32 v230, v230
  v_rcp_f32 v231, v231
  ds_write_b32 v82, v11 offset:3696
  v_rcp_f32 v232, v232
  v_rcp_f32 v233, v233
  ds_write_b32 v82, v12 offset:4224
  v_rcp_f32 v234, v234
  v_rcp_f32 v235, v235
  ds_write_b32 v82, v13 offset:4752
  v_pk_fma_f32 v[228:229], v[228:229], v[220:221], v[216:217] op_sel:[0,0,0] op_sel_hi:[1,0,0]
  v_pk_fma_f32 v[230:231], v[230:231], v[220:221], v[216:217] op_sel:[0,0,0] op_sel_hi:[1,0,0]
  v_pk_fma_f32 v[232:233], v[232:233], v[220:221], v[216:217] op_sel:[0,0,0] op_sel_hi:[1,0,0]
  v_pk_fma_f32 v[234:235], v[234:235], v[220:221], v[216:217] op_sel:[0,0,0] op_sel_hi:[1,0,0]
  v_pk_mul_f32 v[180:181], v[180:181], v[228:229]
  v_pk_mul_f32 v[182:183], v[182:183], v[230:231]
  v_pk_mul_f32 v[184:185], v[184:185], v[232:233]
  v_pk_mul_f32 v[186:187], v[186:187], v[234:235]
  v_cvt_pk_bf16_f32 v236, v180, v181
  v_cvt_pk_bf16_f32 v237, v182, v183
  v_cvt_pk_bf16_f32 v238, v184, v185
  v_cvt_pk_bf16_f32 v239, v186, v187
  buffer_store_dwordx2 v[236:237], v108, s[48:51], s71 offen offset:0 sc1
  buffer_store_dwordx2 v[238:239], v108, s[48:51], s71 offen offset:128 sc1
  s_cmp_lt_u32 s60, 4
  s_cbranch_scc1 F_pr2_21
  s_setprio 1
F_pr2_21:
  s_mov_b32 s71, 2048
  s_add_u32 s70, s80, 1
  s_cmp_ge_u32 s70, s16
  s_cselect_b32 s71, 1073741824, s71
  v_lshlrev_b32 v176, 16, v78
  v_and_b32 v177, 0xffff0000, v78
  v_lshlrev_b32 v178, 16, v79
  v_and_b32 v179, 0xffff0000, v79
  v_pk_mul_f32 v[176:177], v[176:177], v[222:223] op_sel_hi:[1,0]
  v_pk_mul_f32 v[178:179], v[178:179], v[222:223] op_sel_hi:[1,0]
  v_pk_fma_f32 v[180:181], v[168:169], v[244:245], v[176:177] op_sel:[0,0,0] op_sel_hi:[1,0,1]
  v_pk_fma_f32 v[182:183], v[170:171], v[244:245], v[178:179] op_sel:[0,0,0] op_sel_hi:[1,0,1]
  v_pk_fma_f32 v[184:185], v[168:169], v[246:247], v[176:177] op_sel:[0,0,0] op_sel_hi:[1,0,1]
  v_pk_fma_f32 v[186:187], v[170:171], v[246:247], v[178:179] op_sel:[0,0,0] op_sel_hi:[1,0,1]
  ds_write_b32 v82, v14 offset:5280
  ds_write_b32 v82, v15 offset:5808
  v_pk_fma_f32 v[180:181], v[148:149], v[128:129], v[180:181] op_sel:[0,0,0] op_sel_hi:[1,0,1]
  v_pk_fma_f32 v[182:183], v[150:151], v[128:129], v[182:183] op_sel:[0,0,0] op_sel_hi:[1,0,1]
  v_pk_fma_f32 v[184:185], v[152:153], v[130:131], v[184:185] op_sel:[0,0,0] op_sel_hi:[1,0,1]
  v_pk_fma_f32 v[186:187], v[154:155], v[130:131], v[186:187] op_sel:[0,0,0] op_sel_hi:[1,0,1]
  v_exp_f32 v200, v180
  v_exp_f32 v201, v181
  ds_write_b32 v82, v16 offset:6336
  v_exp_f32 v202, v182
  v_exp_f32 v203, v183
  ds_write_b32 v82, v17 offset:6864
  v_exp_f32 v204, v184
  v_exp_f32 v205, v185
  ds_write_b32 v82, v18 offset:7392
  v_exp_f32 v206, v186
  v_exp_f32 v207, v187
  ds_write_b32 v82, v19 offset:7920
  v_pk_add_f32 v[228:229], v[200:201], 2.0 op_sel_hi:[1,0]
  v_pk_add_f32 v[230:231], v[202:203], 2.0 op_sel_hi:[1,0]
  v_pk_add_f32 v[232:233], v[204:205], 2.0 op_sel_hi:[1,0]
  v_pk_add_f32 v[234:235], v[206:207], 2.0 op_sel_hi:[1,0]
  v_pk_fma_f32 v[228:229], v[200:201], v[228:229], 2.0 op_sel_hi:[1,1,0]
  v_pk_fma_f32 v[230:231], v[202:203], v[230:231], 2.0 op_sel_hi:[1,1,0]
  v_pk_fma_f32 v[232:233], v[204:205], v[232:233], 2.0 op_sel_hi:[1,1,0]
  v_pk_fma_f32 v[234:235], v[206:207], v[234:235], 2.0 op_sel_hi:[1,1,0]
  v_rcp_f32 v228, v228
  v_rcp_f32 v229, v229
  ds_write_b32 v82, v20 offset:8448
  v_rcp_f32 v230, v230
  v_rcp_f32 v231, v231
  ds_write_b32 v82, v21 offset:8976
  v_rcp_f32 v232, v232
  v_rcp_f32 v233, v233
  ds_write_b32 v82, v22 offset:9504
  v_rcp_f32 v234, v234
  v_rcp_f32 v235, v235
  ds_write_b32 v82, v23 offset:10032
  v_pk_fma_f32 v[228:229], v[228:229], v[220:221], v[216:217] op_sel:[0,0,0] op_sel_hi:[1,0,0]
  v_pk_fma_f32 v[230:231], v[230:231], v[220:221], v[216:217] op_sel:[0,0,0] op_sel_hi:[1,0,0]
  v_pk_fma_f32 v[232:233], v[232:233], v[220:221], v[216:217] op_sel:[0,0,0] op_sel_hi:[1,0,0]
  v_pk_fma_f32 v[234:235], v[234:235], v[220:221], v[216:217] op_sel:[0,0,0] op_sel_hi:[1,0,0]
  v_pk_mul_f32 v[180:181], v[180:181], v[228:229]
  v_pk_mul_f32 v[182:183], v[182:183], v[230:231]
  v_pk_mul_f32 v[184:185], v[184:185], v[232:233]
  v_pk_mul_f32 v[186:187], v[186:187], v[234:235]
  v_cvt_pk_bf16_f32 v236, v180, v181
  v_cvt_pk_bf16_f32 v237, v182, v183
  v_cvt_pk_bf16_f32 v238, v184, v185
  v_cvt_pk_bf16_f32 v239, v186, v187
  buffer_store_dwordx2 v[236:237], v108, s[48:51], s71 offen offset:0 sc1
  buffer_store_dwordx2 v[238:239], v108, s[48:51], s71 offen offset:128 sc1
  s_mov_b32 s71, 4096
  s_add_u32 s70, s80, 2
  s_cmp_ge_u32 s70, s16
  s_cselect_b32 s71, 1073741824, s71
  v_lshlrev_b32 v176, 16, v80
  v_and_b32 v177, 0xffff0000, v80
  v_lshlrev_b32 v178, 16, v81
  v_and_b32 v179, 0xffff0000, v81
  v_pk_mul_f32 v[176:177], v[176:177], v[222:223] op_sel_hi:[1,0]
  v_pk_mul_f32 v[178:179], v[178:179], v[222:223] op_sel_hi:[1,0]
  v_pk_fma_f32 v[180:181], v[172:173], v[244:245], v[176:177] op_sel:[0,0,0] op_sel_hi:[1,0,1]
  v_pk_fma_f32 v[182:183], v[174:175], v[244:245], v[178:179] op_sel:[0,0,0] op_sel_hi:[1,0,1]
  v_pk_fma_f32 v[184:185], v[172:173], v[246:247], v[176:177] op_sel:[0,0,0] op_sel_hi:[1,0,1]
  v_pk_fma_f32 v[186:187], v[174:175], v[246:247], v[178:179] op_sel:[0,0,0] op_sel_hi:[1,0,1]
  ds_write_b32 v82, v24 offset:10560
  ds_write_b32 v82, v25 offset:11088
  v_pk_fma_f32 v[180:181], v[156:157], v[128:129], v[180:181] op_sel:[0,0,0] op_sel_hi:[1,0,1]
  v_pk_fma_f32 v[182:183], v[158:159], v[128:129], v[182:183] op_sel:[0,0,0] op_sel_hi:[1,0,1]
  v_pk_fma_f32 v[184:185], v[160:161], v[130:131], v[184:185] op_sel:[0,0,0] op_sel_hi:[1,0,1]
  v_pk_fma_f32 v[186:187], v[162:163], v[130:131], v[186:187] op_sel:[0,0,0] op_sel_hi:[1,0,1]
  v_exp_f32 v200, v180
  v_exp_f32 v201, v181
  ds_write_b32 v82, v26 offset:11616
  v_exp_f32 v202, v182
  v_exp_f32 v203, v183
  ds_write_b32 v82, v27 offset:12144
  v_exp_f32 v204, v184
  v_exp_f32 v205, v185
  ds_write_b32 v82, v28 offset:12672
  v_exp_f32 v206, v186
  v_exp_f32 v207, v187
  v_pk_add_f32 v[228:229], v[200:201], 2.0 op_sel_hi:[1,0]
  v_pk_add_f32 v[230:231], v[202:203], 2.0 op_sel_hi:[1,0]
  v_pk_add_f32 v[232:233], v[204:205], 2.0 op_sel_hi:[1,0]
  v_pk_add_f32 v[234:235], v[206:207], 2.0 op_sel_hi:[1,0]
  v_pk_fma_f32 v[228:229], v[200:201], v[228:229], 2.0 op_sel_hi:[1,1,0]
  v_pk_fma_f32 v[230:231], v[202:203], v[230:231], 2.0 op_sel_hi:[1,1,0]
  v_pk_fma_f32 v[232:233], v[204:205], v[232:233], 2.0 op_sel_hi:[1,1,0]
  v_pk_fma_f32 v[234:235], v[206:207], v[234:235], 2.0 op_sel_hi:[1,1,0]
  v_rcp_f32 v228, v228
  v_rcp_f32 v229, v229
  v_rcp_f32 v230, v230
  v_rcp_f32 v231, v231
  v_rcp_f32 v232, v232
  v_rcp_f32 v233, v233
  v_rcp_f32 v234, v234
  v_rcp_f32 v235, v235
  v_pk_fma_f32 v[228:229], v[228:229], v[220:221], v[216:217] op_sel:[0,0,0] op_sel_hi:[1,0,0]
  v_pk_fma_f32 v[230:231], v[230:231], v[220:221], v[216:217] op_sel:[0,0,0] op_sel_hi:[1,0,0]
  v_pk_fma_f32 v[232:233], v[232:233], v[220:221], v[216:217] op_sel:[0,0,0] op_sel_hi:[1,0,0]
  v_pk_fma_f32 v[234:235], v[234:235], v[220:221], v[216:217] op_sel:[0,0,0] op_sel_hi:[1,0,0]
  v_pk_mul_f32 v[180:181], v[180:181], v[228:229]
  v_pk_mul_f32 v[182:183], v[182:183], v[230:231]
  v_pk_mul_f32 v[184:185], v[184:185], v[232:233]
  v_pk_mul_f32 v[186:187], v[186:187], v[234:235]
  v_cvt_pk_bf16_f32 v236, v180, v181
  v_cvt_pk_bf16_f32 v237, v182, v183
  v_cvt_pk_bf16_f32 v238, v184, v185
  v_cvt_pk_bf16_f32 v239, v186, v187
  buffer_store_dwordx2 v[236:237], v108, s[48:51], s71 offen offset:0 sc1
  buffer_store_dwordx2 v[238:239], v108, s[48:51], s71 offen offset:128 sc1
  s_cmp_eq_u32 s69, 0
  s_cbranch_scc1 F_rows7_23
  ds_write_b32 v82, v29 offset:13200
  ds_write_b32 v82, v30 offset:13728
  ds_write_b32 v82, v31 offset:14256
  ds_write_b32 v82, v32 offset:14784
  ds_write_b32 v82, v33 offset:15312
  ds_write_b32 v82, v34 offset:15840
  ds_write_b32 v82, v35 offset:16368
F_rows7_23:
  buffer_load_dwordx4 v[132:135], v111, s[52:55], 0 offen offset:0 sc1
  buffer_load_dwordx4 v[136:139], v111, s[52:55], 0 offen offset:1024 sc1
  s_waitcnt lgkmcnt(0)
  s_mov_b64 exec, 1
  ds_add_u32 v47, v48 offset:16
  s_mov_b64 exec, -1
  s_mov_b32 s72, 0
F_cw_24:
  ds_read_b32 v42, v46 offset:0
  s_add_u32 s72, s72, 1
  s_waitcnt lgkmcnt(0)
  v_cmp_le_u32 vcc, 8, v42
  s_cmp_lt_u32 s72, 262144
  s_cbranch_vccnz F_cwok_25
  s_cbranch_scc1 F_cw_24
F_cwok_25:
  s_mov_b32 s72, 0
F_cw_26:
  ds_read_b32 v42, v47 offset:16
  s_add_u32 s72, s72, 1
  s_waitcnt lgkmcnt(0)
  v_cmp_le_u32 vcc, 4, v42
  s_cmp_lt_u32 s72, 262144
  s_cbranch_vccnz F_cwok_27
  s_cbranch_scc1 F_cw_26
F_cwok_27:
  s_cmp_eq_u32 s66, 3
  s_cbranch_scc1 F_rw3_28
  ds_read_b128 v[140:143], v117 offset:0
  ds_read_b128 v[172:175], v118 offset:16896
  ds_read_b128 v[144:147], v117 offset:64
  ds_read_b128 v[176:179], v118 offset:16960
  ds_read_b128 v[148:151], v117 offset:128
  ds_read_b128 v[180:183], v118 offset:17024
  ds_read_b128 v[152:155], v117 offset:192
  ds_read_b128 v[184:187], v118 offset:17088
  ds_read_b128 v[156:159], v117 offset:256
  ds_read_b128 v[188:191], v118 offset:17152
  ds_read_b128 v[160:163], v117 offset:320
  ds_read_b128 v[192:195], v118 offset:17216
  ds_read_b128 v[164:167], v117 offset:384
  ds_read_b128 v[196:199], v118 offset:17280
  s_waitcnt lgkmcnt(12)
  v_mfma_f32_16x16x32_bf16 v[204:207], v[140:143], v[172:175], 0
  ds_read_b128 v[168:171], v117 offset:448
  ds_read_b128 v[200:203], v118 offset:17344
  s_waitcnt lgkmcnt(12)
  v_mfma_f32_16x16x32_bf16 v[208:211], v[144:147], v[176:179], 0
  s_waitcnt lgkmcnt(10)
  v_mfma_f32_16x16x32_bf16 v[204:207], v[148:151], v[180:183], v[204:207]
  s_waitcnt lgkmcnt(8)
  v_mfma_f32_16x16x32_bf16 v[208:211], v[152:155], v[184:187], v[208:211]
  s_waitcnt lgkmcnt(6)
  v_mfma_f32_16x16x32_bf16 v[204:207], v[156:159], v[188:191], v[204:207]
  s_waitcnt lgkmcnt(4)
  v_mfma_f32_16x16x32_bf16 v[208:211], v[160:163], v[192:195], v[208:211]
  s_waitcnt lgkmcnt(2)
  v_mfma_f32_16x16x32_bf16 v[204:207], v[164:167], v[196:199], v[204:207]
  s_waitcnt lgkmcnt(0)
  v_mfma_f32_16x16x32_bf16 v[208:211], v[168:171], v[200:203], v[208:211]
  s_nop 7
  v_pk_add_f32 v[204:205], v[204:205], v[208:209]
  v_pk_add_f32 v[206:207], v[206:207], v[210:211]
  v_cvt_pk_bf16_f32 v42, v204, v205
  v_cvt_pk_bf16_f32 v43, v206, v207
  ds_write_b16 v95, v42
  ds_write_b16_d16_hi v96, v42
  ds_write_b16 v97, v43
  ds_write_b16_d16_hi v98, v43
  s_branch F_tdone_29
F_rw3_28:
  v_mov_b32 v140, 0
  v_mov_b32 v141, 0
  v_mov_b32 v142, 0
  v_mov_b32 v143, 0
  v_lshl_add_u32 v42, v36, 4, s85
  ds_write_b128 v42, v[140:143]
  ds_write_b128 v42, v[140:143] offset:1024
  s_mov_b64 exec, 0xffff
  ds_write_b128 v42, v[140:143] offset:2048
  s_mov_b64 exec, -1
  v_lshrrev_b32 v42, 3, v36
  v_mul_u32_u24 v42, 4416, v42
  v_lshl_add_u32 v42, v40, 4, v42
  s_add_u32 s72, s84, 4096
  v_add_u32 v42, s72, v42
  s_mov_b32 exec_hi, 0
  ds_write_b128 v42, v[140:143]
  s_mov_b64 exec, -1
  s_add_u32 s72, s83, 2820
  v_mov_b32 v42, s72
  ds_write_b16 v42, v140
F_tdone_29:
  s_waitcnt lgkmcnt(0)
  s_mov_b64 exec, 1
  ds_add_u32 v47, v48 offset:20
  s_mov_b64 exec, -1
  s_mov_b32 s72, 0
F_cw_30:
  ds_read_b32 v42, v47 offset:20
  s_add_u32 s72, s72, 1
  s_waitcnt lgkmcnt(0)
  v_cmp_le_u32 vcc, 4, v42
  s_cmp_lt_u32 s72, 262144
  s_cbranch_vccnz F_cwok_31
  s_cbranch_scc1 F_cw_30
F_cwok_31:
  ds_read_u16 v213, v84
  ds_read_u16 v219, v85
  ds_read_u16 v214, v86
  ds_read_u16 v220, v87
  ds_read_u16 v215, v88
  ds_read_u16 v221, v89
  ds_read_u16 v216, v90
  ds_read_u16 v222, v91
  ds_read_u16 v217, v92
  ds_read_u16 v223, v93
  ds_read_u16 v218, v94
  v_lshl_add_u32 v42, v83, 4, s84
  s_waitcnt lgkmcnt(0)
  v_lshl_or_b32 v213, v219, 16, v213
  v_lshl_or_b32 v214, v220, 16, v214
  v_lshl_or_b32 v215, v221, 16, v215
  v_lshl_or_b32 v216, v222, 16, v216
  v_lshl_or_b32 v217, v223, 16, v217
  v_alignbit_b32 v228, v214, v213, 16
  v_alignbit_b32 v229, v215, v214, 16
  v_alignbit_b32 v230, v216, v215, 16
  v_alignbit_b32 v231, v217, v216, 16
  v_alignbit_b32 v232, v215, v214, 16
  v_alignbit_b32 v233, v216, v215, 16
  v_alignbit_b32 v234, v217, v216, 16
  v_alignbit_b32 v235, v218, v217, 16
  ds_write_b128 v42, v[214:217] offset:8832
  v_mov_b32 v224, v213
  v_mov_b32 v225, v214
  v_mov_b32 v226, v215
  v_mov_b32 v227, v216
  ds_write_b128 v42, v[228:231] offset:4416
  ds_write_b128 v42, v[232:235] offset:13248
  ds_write_b128 v42, v[224:227]
  s_waitcnt vmcnt(0)
  v_cmp_ne_u64 vcc, v[134:135], v[56:57]
  v_cmp_ne_u64 s[18:19], v[138:139], v[56:57]
  s_nop 1
  s_or_b64 vcc, vcc, s[18:19]
  s_cbranch_vccnz F_uslow_32
F_uback_33:
  ds_write_b64 v112, v[132:133] offset:0
  ds_write_b64 v112, v[136:137] offset:576
  s_waitcnt lgkmcnt(0)
  s_mov_b64 exec, 1
  ds_add_u32 v47, v48 offset:24
  s_mov_b64 exec, -1
  s_mov_b64 exec, 1
  ds_add_rtn_u32 v43, v46, v48 offset:4
  s_mov_b64 exec, -1
  s_mov_b32 s72, 0
F_cw_34:
  ds_read_b32 v42, v47 offset:24
  s_add_u32 s72, s72, 1
  s_waitcnt lgkmcnt(0)
  v_cmp_le_u32 vcc, 4, v42
  s_cmp_lt_u32 s72, 262144
  s_cbranch_vccnz F_cwok_35
  s_cbranch_scc1 F_cw_34
F_cwok_35:
  v_readfirstlane_b32 s72, v43
  s_lshl_b32 s71, s61, 3
  s_add_u32 s71, s71, s62
  s_lshl_b32 s70, s71, 7
  s_add_u32 s70, s70, 12615680
  s_cmp_eq_u32 s72, 7
  s_cselect_b32 s70, s70, 1073741824
  v_mov_b32 v45, s70
  s_mov_b64 exec, 1
  buffer_store_dwordx2 v[56:57], v45, s[52:55], 0 offen sc1
  s_mov_b64 exec, -1
  s_setprio 0
  s_cmp_eq_u32 s66, 2
  s_cbranch_scc1 F_p2_36
  s_cmp_eq_u32 s66, 3
  s_cbranch_scc1 F_p3_37
  s_mov_b32 s10, 1
  s_mul_i32 s11, s66, 12
  s_add_u32 s11, s11, 11
  s_lshl_b32 s70, s11, 7
  s_add_u32 s70, s70, 96
  v_subrev_u32 v140, s70, v99
  s_lshl_b32 s70, s10, 4
  s_sub_u32 s70, s70, s11
  s_mul_i32 s70, s70, 144
  v_add_u32 v141, s70, v100
  s_cmp_ge_u32 s60, 4
  s_cbranch_scc1 F_young_39
  v_add_u32 v43, 16, v46
  s_mov_b32 s72, 0
F_cw_40:
  ds_read_b32 v42, v43 offset:20
  s_add_u32 s72, s72, 1
  s_waitcnt lgkmcnt(0)
  v_cmp_le_u32 vcc, 4, v42
  s_cmp_lt_u32 s72, 262144
  s_cbranch_vccnz F_cwok_41
  s_cbranch_scc1 F_cw_40
F_cwok_41:
  s_mul_i32 s8, s9, s5
  s_add_u32 s9, s9, 1
  s_add_u32 s8, s8, s6
  s_cmp_eq_u32 s9, 11
  s_cselect_b32 s9, 0, s9
  s_add_u32 s72, s8, 720896
  s_add_u32 m0, s7, 0
  s_nop 0
  buffer_load_dwordx4 v114, s[44:47], s8 offen sc1 lds
  s_add_u32 m0, s7, 1024
  s_add_u32 s8, s8, s4
  buffer_load_dwordx4 v114, s[44:47], s8 offen sc1 lds
  s_add_u32 m0, s7, 2048
  s_add_u32 s8, s8, s4
  buffer_load_dwordx4 v114, s[44:47], s8 offen sc1 lds
  s_add_u32 m0, s7, 3072
  s_add_u32 s8, s8, s4
  buffer_load_dwordx4 v114, s[44:47], s8 offen sc1 lds
  s_mov_b32 s8, s72
  s_add_u32 m0, s7, 16384
  s_nop 0
  buffer_load_dwordx4 v114, s[44:47], s8 offen sc1 lds
  s_add_u32 m0, s7, 17408
  s_add_u32 s8, s8, s4
  buffer_load_dwordx4 v114, s[44:47], s8 offen sc1 lds
  s_add_u32 m0, s7, 18432
  s_add_u32 s8, s8, s4
  buffer_load_dwordx4 v114, s[44:47], s8 offen sc1 lds
  s_add_u32 m0, s7, 19456
  s_add_u32 s8, s8, s4
  buffer_load_dwordx4 v114, s[44:47], s8 offen sc1 lds
  s_mul_i32 s8, s9, s5
  s_add_u32 s9, s9, 1
  s_add_u32 s8, s8, s6
  s_cmp_eq_u32 s9, 11
  s_cselect_b32 s9, 0, s9
  s_add_u32 s72, s8, 720896
  s_add_u32 m0, s7, 32768
  s_nop 0
  buffer_load_dwordx4 v114, s[44:47], s8 offen sc1 lds
  s_add_u32 m0, s7, 33792
  s_add_u32 s8, s8, s4
  buffer_load_dwordx4 v114, s[44:47], s8 offen sc1 lds
  s_add_u32 m0, s7, 34816
  s_add_u32 s8, s8, s4
  buffer_load_dwordx4 v114, s[44:47], s8 offen sc1 lds
  s_add_u32 m0, s7, 35840
  s_add_u32 s8, s8, s4
  buffer_load_dwordx4 v114, s[44:47], s8 offen sc1 lds
  s_mov_b32 s8, s72
  s_add_u32 m0, s7, 49152
  s_nop 0
  buffer_load_dwordx4 v114, s[44:47], s8 offen sc1 lds
  s_add_u32 m0, s7, 50176
  s_add_u32 s8, s8, s4
  buffer_load_dwordx4 v114, s[44:47], s8 offen sc1 lds
  s_add_u32 m0, s7, 51200
  s_add_u32 s8, s8, s4
  buffer_load_dwordx4 v114, s[44:47], s8 offen sc1 lds
  s_add_u32 m0, s7, 52224
  s_add_u32 s8, s8, s4
  buffer_load_dwordx4 v114, s[44:47], s8 offen sc1 lds
  s_branch F_young_39_j
F_young_39:
  s_add_u32 s9, s9, 2
  s_cmp_ge_u32 s9, 11
  s_cselect_b32 s70, 11, 0
  s_sub_u32 s9, s9, s70
F_young_39_j:
  ds_read_b64 v[204:205], v141 offset:1584
  ds_read_b64 v[206:207], v141 offset:1616
  ds_read_b64 v[182:183], v140 offset:1504
  ds_read_b64 v[184:185], v140 offset:1536
  ds_read_b64 v[180:181], v140 offset:1472
  ds_read_b64 v[178:179], v140 offset:1440
  ds_read_b64 v[176:177], v140 offset:1408
  ds_read_b64 v[208:209], v141 offset:1648
  ds_read_b64 v[210:211], v141 offset:1680
  ds_read_b64 v[186:187], v140 offset:1568
  ds_read_b64 v[188:189], v140 offset:1600
  s_waitcnt lgkmcnt(4)
  v_mfma_f32_16x16x32_bf16 v[144:147], v[182:185], v[204:207], 0
  ds_read_b64 v[212:213], v141 offset:1440
  ds_read_b64 v[214:215], v141 offset:1472
  v_mfma_f32_16x16x32_bf16 v[148:151], v[180:183], v[204:207], 0
  ds_read_b64 v[196:197], v140 offset:1376
  v_mfma_f32_16x16x32_bf16 v[152:155], v[178:181], v[204:207], 0
  ds_read_b64 v[198:199], v140 offset:1408
  ds_read_b64 v[194:195], v140 offset:1344
  v_mfma_f32_16x16x32_bf16 v[156:159], v[176:179], v[204:207], 0
  ds_read_b64 v[192:193], v140 offset:1312
  s_waitcnt lgkmcnt(6)
  v_mfma_f32_16x16x32_bf16 v[156:159], v[180:183], v[208:211], v[156:159]
  ds_read_b64 v[190:191], v140 offset:1280
  ds_read_b64 v[216:217], v141 offset:1504
  v_mfma_f32_16x16x32_bf16 v[152:155], v[182:185], v[208:211], v[152:155]
  ds_read_b64 v[218:219], v141 offset:1536
  v_mfma_f32_16x16x32_bf16 v[148:151], v[184:187], v[208:211], v[148:151]
  ds_read_b64 v[200:201], v140 offset:1440
  v_mfma_f32_16x16x32_bf16 v[144:147], v[186:189], v[208:211], v[144:147]
  ds_read_b64 v[202:203], v140 offset:1472
  s_waitcnt lgkmcnt(4)
  v_mfma_f32_16x16x32_bf16 v[144:147], v[196:199], v[212:215], v[144:147]
  ds_read_b64 v[204:205], v141 offset:1296
  ds_read_b64 v[206:207], v141 offset:1328
  v_mfma_f32_16x16x32_bf16 v[148:151], v[194:197], v[212:215], v[148:151]
  ds_read_b64 v[182:183], v140 offset:1248
  v_mfma_f32_16x16x32_bf16 v[152:155], v[192:195], v[212:215], v[152:155]
  ds_read_b64 v[184:185], v140 offset:1280
  ds_read_b64 v[180:181], v140 offset:1216
  v_mfma_f32_16x16x32_bf16 v[156:159], v[190:193], v[212:215], v[156:159]
  ds_read_b64 v[178:179], v140 offset:1184
  s_waitcnt lgkmcnt(6)
  v_mfma_f32_16x16x32_bf16 v[156:159], v[194:197], v[216:219], v[156:159]
  ds_read_b64 v[176:177], v140 offset:1152
  ds_read_b64 v[208:209], v141 offset:1360
  v_mfma_f32_16x16x32_bf16 v[152:155], v[196:199], v[216:219], v[152:155]
  ds_read_b64 v[210:211], v141 offset:1392
  v_mfma_f32_16x16x32_bf16 v[148:151], v[198:201], v[216:219], v[148:151]
  ds_read_b64 v[186:187], v140 offset:1312
  v_mfma_f32_16x16x32_bf16 v[144:147], v[200:203], v[216:219], v[144:147]
  ds_read_b64 v[188:189], v140 offset:1344
  s_waitcnt lgkmcnt(4)
  v_mfma_f32_16x16x32_bf16 v[144:147], v[182:185], v[204:207], v[144:147]
  ds_read_b64 v[212:213], v141 offset:1152
  ds_read_b64 v[214:215], v141 offset:1184
  v_mfma_f32_16x16x32_bf16 v[148:151], v[180:183], v[204:207], v[148:151]
  ds_read_b64 v[196:197], v140 offset:1120
  v_mfma_f32_16x16x32_bf16 v[152:155], v[178:181], v[204:207], v[152:155]
  ds_read_b64 v[198:199], v140 offset:1152
  ds_read_b64 v[194:195], v140 offset:1088
  v_mfma_f32_16x16x32_bf16 v[156:159], v[176:179], v[204:207], v[156:159]
  ds_read_b64 v[192:193], v140 offset:1056
  s_waitcnt lgkmcnt(6)
  v_mfma_f32_16x16x32_bf16 v[156:159], v[180:183], v[208:211], v[156:159]
  ds_read_b64 v[190:191], v140 offset:1024
  ds_read_b64 v[216:217], v141 offset:1216
  v_mfma_f32_16x16x32_bf16 v[152:155], v[182:185], v[208:211], v[152:155]
  ds_read_b64 v[218:219], v141 offset:1248
  v_mfma_f32_16x16x32_bf16 v[148:151], v[184:187], v[208:211], v[148:151]
  ds_read_b64 v[200:201], v140 offset:1184
  v_mfma_f32_16x16x32_bf16 v[144:147], v[186:189], v[208:211], v[144:147]
  ds_read_b64 v[202:203], v140 offset:1216
  s_waitcnt lgkmcnt(4)
  v_mfma_f32_16x16x32_bf16 v[144:147], v[196:199], v[212:215], v[144:147]
  ds_read_b64 v[204:205], v141 offset:1008
  ds_read_b64 v[206:207], v141 offset:1040
  v_mfma_f32_16x16x32_bf16 v[148:151], v[194:197], v[212:215], v[148:151]
  ds_read_b64 v[182:183], v140 offset:992
  v_mfma_f32_16x16x32_bf16 v[152:155], v[192:195], v[212:215], v[152:155]
  ds_read_b64 v[184:185], v140 offset:1024
  ds_read_b64 v[180:181], v140 offset:960
  v_mfma_f32_16x16x32_bf16 v[156:159], v[190:193], v[212:215], v[156:159]
  ds_read_b64 v[178:179], v140 offset:928
  s_waitcnt lgkmcnt(6)
  v_mfma_f32_16x16x32_bf16 v[156:159], v[194:197], v[216:219], v[156:159]
  ds_read_b64 v[176:177], v140 offset:896
  ds_read_b64 v[208:209], v141 offset:1072
  v_mfma_f32_16x16x32_bf16 v[152:155], v[196:199], v[216:219], v[152:155]
  ds_read_b64 v[210:211], v141 offset:1104
  v_mfma_f32_16x16x32_bf16 v[148:151], v[198:201], v[216:219], v[148:151]
  ds_read_b64 v[186:187], v140 offset:1056
  v_mfma_f32_16x16x32_bf16 v[144:147], v[200:203], v[216:219], v[144:147]
  ds_read_b64 v[188:189], v140 offset:1088
  s_waitcnt lgkmcnt(4)
  v_mfma_f32_16x16x32_bf16 v[144:147], v[182:185], v[204:207], v[144:147]
  ds_read_b64 v[212:213], v141 offset:864
  ds_read_b64 v[214:215], v141 offset:896
  v_mfma_f32_16x16x32_bf16 v[148:151], v[180:183], v[204:207], v[148:151]
  ds_read_b64 v[196:197], v140 offset:864
  v_mfma_f32_16x16x32_bf16 v[152:155], v[178:181], v[204:207], v[152:155]
  ds_read_b64 v[198:199], v140 offset:896
  ds_read_b64 v[194:195], v140 offset:832
  v_mfma_f32_16x16x32_bf16 v[156:159], v[176:179], v[204:207], v[156:159]
  ds_read_b64 v[192:193], v140 offset:800
  s_waitcnt lgkmcnt(6)
  v_mfma_f32_16x16x32_bf16 v[156:159], v[180:183], v[208:211], v[156:159]
  ds_read_b64 v[190:191], v140 offset:768
  ds_read_b64 v[216:217], v141 offset:928
  v_mfma_f32_16x16x32_bf16 v[152:155], v[182:185], v[208:211], v[152:155]
  ds_read_b64 v[218:219], v141 offset:960
  v_mfma_f32_16x16x32_bf16 v[148:151], v[184:187], v[208:211], v[148:151]
  ds_read_b64 v[200:201], v140 offset:928
  v_mfma_f32_16x16x32_bf16 v[144:147], v[186:189], v[208:211], v[144:147]
  ds_read_b64 v[202:203], v140 offset:960
  s_waitcnt lgkmcnt(4)
  v_mfma_f32_16x16x32_bf16 v[144:147], v[196:199], v[212:215], v[144:147]
  ds_read_b64 v[204:205], v141 offset:720
  ds_read_b64 v[206:207], v141 offset:752
  v_mfma_f32_16x16x32_bf16 v[148:151], v[194:197], v[212:215], v[148:151]
  ds_read_b64 v[182:183], v140 offset:736
  v_mfma_f32_16x16x32_bf16 v[152:155], v[192:195], v[212:215], v[152:155]
  ds_read_b64 v[184:185], v140 offset:768
  ds_read_b64 v[180:181], v140 offset:704
  v_mfma_f32_16x16x32_bf16 v[156:159], v[190:193], v[212:215], v[156:159]
  ds_read_b64 v[178:179], v140 offset:672
  s_waitcnt lgkmcnt(6)
  v_mfma_f32_16x16x32_bf16 v[156:159], v[194:197], v[216:219], v[156:159]
  ds_read_b64 v[176:177], v140 offset:640
  ds_read_b64 v[208:209], v141 offset:784
  v_mfma_f32_16x16x32_bf16 v[152:155], v[196:199], v[216:219], v[152:155]
  ds_read_b64 v[210:211], v141 offset:816
  v_mfma_f32_16x16x32_bf16 v[148:151], v[198:201], v[216:219], v[148:151]
  ds_read_b64 v[186:187], v140 offset:800
  v_mfma_f32_16x16x32_bf16 v[144:147], v[200:203], v[216:219], v[144:147]
  ds_read_b64 v[188:189], v140 offset:832
  s_waitcnt lgkmcnt(4)
  v_mfma_f32_16x16x32_bf16 v[144:147], v[182:185], v[204:207], v[144:147]
  ds_read_b64 v[212:213], v141 offset:576
  ds_read_b64 v[214:215], v141 offset:608
  v_mfma_f32_16x16x32_bf16 v[148:151], v[180:183], v[204:207], v[148:151]
  ds_read_b64 v[196:197], v140 offset:608
  v_mfma_f32_16x16x32_bf16 v[152:155], v[178:181], v[204:207], v[152:155]
  ds_read_b64 v[198:199], v140 offset:640
  ds_read_b64 v[194:195], v140 offset:576
  v_mfma_f32_16x16x32_bf16 v[156:159], v[176:179], v[204:207], v[156:159]
  ds_read_b64 v[192:193], v140 offset:544
  s_waitcnt lgkmcnt(6)
  v_mfma_f32_16x16x32_bf16 v[156:159], v[180:183], v[208:211], v[156:159]
  ds_read_b64 v[190:191], v140 offset:512
  ds_read_b64 v[216:217], v141 offset:640
  v_mfma_f32_16x16x32_bf16 v[152:155], v[182:185], v[208:211], v[152:155]
  ds_read_b64 v[218:219], v141 offset:672
  v_mfma_f32_16x16x32_bf16 v[148:151], v[184:187], v[208:211], v[148:151]
  ds_read_b64 v[200:201], v140 offset:672
  v_mfma_f32_16x16x32_bf16 v[144:147], v[186:189], v[208:211], v[144:147]
  ds_read_b64 v[202:203], v140 offset:704
  buffer_load_dwordx2 v[58:59], v60, s[52:55], 0 offen sc1
  s_waitcnt lgkmcnt(4)
  v_mfma_f32_16x16x32_bf16 v[144:147], v[196:199], v[212:215], v[144:147]
  ds_read_b64 v[204:205], v141 offset:432
  ds_read_b64 v[206:207], v141 offset:464
  v_mfma_f32_16x16x32_bf16 v[148:151], v[194:197], v[212:215], v[148:151]
  ds_read_b64 v[182:183], v140 offset:480
  v_mfma_f32_16x16x32_bf16 v[152:155], v[192:195], v[212:215], v[152:155]
  ds_read_b64 v[184:185], v140 offset:512
  ds_read_b64 v[180:181], v140 offset:448
  v_mfma_f32_16x16x32_bf16 v[156:159], v[190:193], v[212:215], v[156:159]
  ds_read_b64 v[178:179], v140 offset:416
  s_waitcnt lgkmcnt(6)
  v_mfma_f32_16x16x32_bf16 v[156:159], v[194:197], v[216:219], v[156:159]
  ds_read_b64 v[176:177], v140 offset:384
  ds_read_b64 v[208:209], v141 offset:496
  v_mfma_f32_16x16x32_bf16 v[152:155], v[196:199], v[216:219], v[152:155]
  ds_read_b64 v[210:211], v141 offset:528
  v_mfma_f32_16x16x32_bf16 v[148:151], v[198:201], v[216:219], v[148:151]
  ds_read_b64 v[186:187], v140 offset:544
  v_mfma_f32_16x16x32_bf16 v[144:147], v[200:203], v[216:219], v[144:147]
  ds_read_b64 v[188:189], v140 offset:576
  s_waitcnt lgkmcnt(4)
  v_mfma_f32_16x16x32_bf16 v[144:147], v[182:185], v[204:207], v[144:147]
  ds_read_b64 v[212:213], v141 offset:288
  ds_read_b64 v[214:215], v141 offset:320
  v_mfma_f32_16x16x32_bf16 v[148:151], v[180:183], v[204:207], v[148:151]
  ds_read_b64 v[196:197], v140 offset:352
  v_mfma_f32_16x16x32_bf16 v[152:155], v[178:181], v[204:207], v[152:155]
  ds_read_b64 v[198:199], v140 offset:384
  ds_read_b64 v[194:195], v140 offset:320
  v_mfma_f32_16x16x32_bf16 v[156:159], v[176:179], v[204:207], v[156:159]
  ds_read_b64 v[192:193], v140 offset:288
  s_waitcnt lgkmcnt(6)
  v_mfma_f32_16x16x32_bf16 v[156:159], v[180:183], v[208:211], v[156:159]
  ds_read_b64 v[190:191], v140 offset:256
  ds_read_b64 v[216:217], v141 offset:352
  v_mfma_f32_16x16x32_bf16 v[152:155], v[182:185], v[208:211], v[152:155]
  ds_read_b64 v[218:219], v141 offset:384
  v_mfma_f32_16x16x32_bf16 v[148:151], v[184:187], v[208:211], v[148:151]
  ds_read_b64 v[200:201], v140 offset:416
  v_mfma_f32_16x16x32_bf16 v[144:147], v[186:189], v[208:211], v[144:147]
  ds_read_b64 v[202:203], v140 offset:448
  s_waitcnt lgkmcnt(4)
  v_mfma_f32_16x16x32_bf16 v[144:147], v[196:199], v[212:215], v[144:147]
  ds_read_b64 v[204:205], v141 offset:144
  ds_read_b64 v[206:207], v141 offset:176
  v_mfma_f32_16x16x32_bf16 v[148:151], v[194:197], v[212:215], v[148:151]
  ds_read_b64 v[182:183], v140 offset:224
  v_mfma_f32_16x16x32_bf16 v[152:155], v[192:195], v[212:215], v[152:155]
  ds_read_b64 v[184:185], v140 offset:256
  ds_read_b64 v[180:181], v140 offset:192
  v_mfma_f32_16x16x32_bf16 v[156:159], v[190:193], v[212:215], v[156:159]
  ds_read_b64 v[178:179], v140 offset:160
  s_waitcnt lgkmcnt(6)
  v_mfma_f32_16x16x32_bf16 v[156:159], v[194:197], v[216:219], v[156:159]
  ds_read_b64 v[176:177], v140 offset:128
  ds_read_b64 v[208:209], v141 offset:208
  v_mfma_f32_16x16x32_bf16 v[152:155], v[196:199], v[216:219], v[152:155]
  ds_read_b64 v[210:211], v141 offset:240
  v_mfma_f32_16x16x32_bf16 v[148:151], v[198:201], v[216:219], v[148:151]
  ds_read_b64 v[186:187], v140 offset:288
  v_mfma_f32_16x16x32_bf16 v[144:147], v[200:203], v[216:219], v[144:147]
  ds_read_b64 v[188:189], v140 offset:320
  s_waitcnt lgkmcnt(4)
  v_mfma_f32_16x16x32_bf16 v[144:147], v[182:185], v[204:207], v[144:147]
  ds_read_b64 v[212:213], v141 offset:0
  ds_read_b64 v[214:215], v141 offset:32
  v_mfma_f32_16x16x32_bf16 v[148:151], v[180:183], v[204:207], v[148:151]
  ds_read_b64 v[196:197], v140 offset:96
  v_mfma_f32_16x16x32_bf16 v[152:155], v[178:181], v[204:207], v[152:155]
  ds_read_b64 v[198:199], v140 offset:128
  ds_read_b64 v[194:195], v140 offset:64
  v_mfma_f32_16x16x32_bf16 v[156:159], v[176:179], v[204:207], v[156:159]
  ds_read_b64 v[192:193], v140 offset:32
  s_waitcnt lgkmcnt(6)
  v_mfma_f32_16x16x32_bf16 v[156:159], v[180:183], v[208:211], v[156:159]
  ds_read_b64 v[190:191], v140 offset:0
  ds_read_b64 v[216:217], v141 offset:64
  v_mfma_f32_16x16x32_bf16 v[152:155], v[182:185], v[208:211], v[152:155]
  ds_read_b64 v[218:219], v141 offset:96
  v_mfma_f32_16x16x32_bf16 v[148:151], v[184:187], v[208:211], v[148:151]
  ds_read_b64 v[200:201], v140 offset:160
  v_mfma_f32_16x16x32_bf16 v[144:147], v[186:189], v[208:211], v[144:147]
  ds_read_b64 v[202:203], v140 offset:192
  s_waitcnt lgkmcnt(0)
  v_mfma_f32_16x16x32_bf16 v[144:147], v[196:199], v[212:215], v[144:147]
  v_mfma_f32_16x16x32_bf16 v[148:151], v[194:197], v[212:215], v[148:151]
  v_mfma_f32_16x16x32_bf16 v[152:155], v[192:195], v[212:215], v[152:155]
  v_mfma_f32_16x16x32_bf16 v[156:159], v[190:193], v[212:215], v[156:159]
  v_mfma_f32_16x16x32_bf16 v[156:159], v[194:197], v[216:219], v[156:159]
  v_mfma_f32_16x16x32_bf16 v[152:155], v[196:199], v[216:219], v[152:155]
  v_mfma_f32_16x16x32_bf16 v[148:151], v[198:201], v[216:219], v[148:151]
  v_mfma_f32_16x16x32_bf16 v[144:147], v[200:203], v[216:219], v[144:147]
  s_nop 3
  s_mul_i32 s70, s67, 20480
  s_lshl_b32 s71, s66, 12
  s_add_u32 s70, s70, s71
  s_add_u32 s70, s70, 120832
  v_add_u32 v42, s70, v50
  ds_write_b128 v42, v[144:147] offset:0
  v_xor_b32 v43, 64, v42
  ds_write_b128 v43, v[148:151] offset:1024
  v_xor_b32 v43, 128, v42
  ds_write_b128 v43, v[152:155] offset:2048
  v_xor_b32 v43, 192, v42
  ds_write_b128 v43, v[156:159] offset:3072
  s_branch F_cdone_38
F_p3_37:
  s_mov_b32 s10, 0
  s_mov_b32 s11, 15
  s_mov_b32 s12, 4
  s_lshl_b32 s70, s11, 7
  s_add_u32 s70, s70, 96
  v_subrev_u32 v140, s70, v99
  s_lshl_b32 s70, s10, 4
  s_sub_u32 s70, s70, s11
  s_mul_i32 s70, s70, 144
  v_add_u32 v141, s70, v100
  ds_read_b64 v[204:205], v141 offset:1584
  ds_read_b64 v[206:207], v141 offset:1616
  ds_read_b64 v[182:183], v140 offset:1504
  ds_read_b64 v[184:185], v140 offset:1536
  ds_read_b64 v[180:181], v140 offset:1472
  ds_read_b64 v[178:179], v140 offset:1440
  ds_read_b64 v[176:177], v140 offset:1408
  ds_read_b64 v[208:209], v141 offset:1648
  ds_read_b64 v[210:211], v141 offset:1680
  ds_read_b64 v[186:187], v140 offset:1568
  ds_read_b64 v[188:189], v140 offset:1600
  s_waitcnt lgkmcnt(4)
  v_mfma_f32_16x16x32_bf16 v[144:147], v[182:185], v[204:207], 0
  ds_read_b64 v[212:213], v141 offset:1440
  ds_read_b64 v[214:215], v141 offset:1472
  v_mfma_f32_16x16x32_bf16 v[148:151], v[180:183], v[204:207], 0
  ds_read_b64 v[196:197], v140 offset:1376
  v_mfma_f32_16x16x32_bf16 v[152:155], v[178:181], v[204:207], 0
  ds_read_b64 v[198:199], v140 offset:1408
  ds_read_b64 v[194:195], v140 offset:1344
  v_mfma_f32_16x16x32_bf16 v[156:159], v[176:179], v[204:207], 0
  ds_read_b64 v[192:193], v140 offset:1312
  s_waitcnt lgkmcnt(6)
  v_mfma_f32_16x16x32_bf16 v[156:159], v[180:183], v[208:211], v[156:159]
  ds_read_b64 v[190:191], v140 offset:1280
  ds_read_b64 v[216:217], v141 offset:1504
  v_mfma_f32_16x16x32_bf16 v[152:155], v[182:185], v[208:211], v[152:155]
  ds_read_b64 v[218:219], v141 offset:1536
  v_mfma_f32_16x16x32_bf16 v[148:151], v[184:187], v[208:211], v[148:151]
  ds_read_b64 v[200:201], v140 offset:1440
  v_mfma_f32_16x16x32_bf16 v[144:147], v[186:189], v[208:211], v[144:147]
  ds_read_b64 v[202:203], v140 offset:1472
  s_waitcnt lgkmcnt(4)
  v_mfma_f32_16x16x32_bf16 v[144:147], v[196:199], v[212:215], v[144:147]
  ds_read_b64 v[204:205], v141 offset:1296
  ds_read_b64 v[206:207], v141 offset:1328
  v_mfma_f32_16x16x32_bf16 v[148:151], v[194:197], v[212:215], v[148:151]
  ds_read_b64 v[182:183], v140 offset:1248
  v_mfma_f32_16x16x32_bf16 v[152:155], v[192:195], v[212:215], v[152:155]
  ds_read_b64 v[184:185], v140 offset:1280
  ds_read_b64 v[180:181], v140 offset:1216
  v_mfma_f32_16x16x32_bf16 v[156:159], v[190:193], v[212:215], v[156:159]
  ds_read_b64 v[178:179], v140 offset:1184
  s_waitcnt lgkmcnt(6)
  v_mfma_f32_16x16x32_bf16 v[156:159], v[194:197], v[216:219], v[156:159]
  ds_read_b64 v[176:177], v140 offset:1152
  ds_read_b64 v[208:209], v141 offset:1360
  v_mfma_f32_16x16x32_bf16 v[152:155], v[196:199], v[216:219], v[152:155]
  ds_read_b64 v[210:211], v141 offset:1392
  v_mfma_f32_16x16x32_bf16 v[148:151], v[198:201], v[216:219], v[148:151]
  ds_read_b64 v[186:187], v140 offset:1312
  v_mfma_f32_16x16x32_bf16 v[144:147], v[200:203], v[216:219], v[144:147]
  ds_read_b64 v[188:189], v140 offset:1344
  s_waitcnt lgkmcnt(4)
  v_mfma_f32_16x16x32_bf16 v[144:147], v[182:185], v[204:207], v[144:147]
  ds_read_b64 v[212:213], v141 offset:1152
  ds_read_b64 v[214:215], v141 offset:1184
  v_mfma_f32_16x16x32_bf16 v[148:151], v[180:183], v[204:207], v[148:151]
  ds_read_b64 v[196:197], v140 offset:1120
  v_mfma_f32_16x16x32_bf16 v[152:155], v[178:181], v[204:207], v[152:155]
  ds_read_b64 v[198:199], v140 offset:1152
  ds_read_b64 v[194:195], v140 offset:1088
  v_mfma_f32_16x16x32_bf16 v[156:159], v[176:179], v[204:207], v[156:159]
  ds_read_b64 v[192:193], v140 offset:1056
  s_waitcnt lgkmcnt(6)
  v_mfma_f32_16x16x32_bf16 v[156:159], v[180:183], v[208:211], v[156:159]
  ds_read_b64 v[190:191], v140 offset:1024
  ds_read_b64 v[216:217], v141 offset:1216
  v_mfma_f32_16x16x32_bf16 v[152:155], v[182:185], v[208:211], v[152:155]
  ds_read_b64 v[218:219], v141 offset:1248
  v_mfma_f32_16x16x32_bf16 v[148:151], v[184:187], v[208:211], v[148:151]
  ds_read_b64 v[200:201], v140 offset:1184
  v_mfma_f32_16x16x32_bf16 v[144:147], v[186:189], v[208:211], v[144:147]
  ds_read_b64 v[202:203], v140 offset:1216
  s_waitcnt lgkmcnt(4)
  v_mfma_f32_16x16x32_bf16 v[144:147], v[196:199], v[212:215], v[144:147]
  ds_read_b64 v[204:205], v141 offset:1008
  ds_read_b64 v[206:207], v141 offset:1040
  v_mfma_f32_16x16x32_bf16 v[148:151], v[194:197], v[212:215], v[148:151]
  ds_read_b64 v[182:183], v140 offset:992
  v_mfma_f32_16x16x32_bf16 v[152:155], v[192:195], v[212:215], v[152:155]
  ds_read_b64 v[184:185], v140 offset:1024
  ds_read_b64 v[180:181], v140 offset:960
  v_mfma_f32_16x16x32_bf16 v[156:159], v[190:193], v[212:215], v[156:159]
  ds_read_b64 v[178:179], v140 offset:928
  s_waitcnt lgkmcnt(6)
  v_mfma_f32_16x16x32_bf16 v[156:159], v[194:197], v[216:219], v[156:159]
  ds_read_b64 v[176:177], v140 offset:896
  ds_read_b64 v[208:209], v141 offset:1072
  v_mfma_f32_16x16x32_bf16 v[152:155], v[196:199], v[216:219], v[152:155]
  ds_read_b64 v[210:211], v141 offset:1104
  v_mfma_f32_16x16x32_bf16 v[148:151], v[198:201], v[216:219], v[148:151]
  ds_read_b64 v[186:187], v140 offset:1056
  v_mfma_f32_16x16x32_bf16 v[144:147], v[200:203], v[216:219], v[144:147]
  ds_read_b64 v[188:189], v140 offset:1088
  s_waitcnt lgkmcnt(4)
  v_mfma_f32_16x16x32_bf16 v[144:147], v[182:185], v[204:207], v[144:147]
  ds_read_b64 v[212:213], v141 offset:864
  ds_read_b64 v[214:215], v141 offset:896
  v_mfma_f32_16x16x32_bf16 v[148:151], v[180:183], v[204:207], v[148:151]
  ds_read_b64 v[196:197], v140 offset:864
  v_mfma_f32_16x16x32_bf16 v[152:155], v[178:181], v[204:207], v[152:155]
  ds_read_b64 v[198:199], v140 offset:896
  ds_read_b64 v[194:195], v140 offset:832
  v_mfma_f32_16x16x32_bf16 v[156:159], v[176:179], v[204:207], v[156:159]
  ds_read_b64 v[192:193], v140 offset:800
  s_waitcnt lgkmcnt(6)
  v_mfma_f32_16x16x32_bf16 v[156:159], v[180:183], v[208:211], v[156:159]
  ds_read_b64 v[190:191], v140 offset:768
  ds_read_b64 v[216:217], v141 offset:928
  v_mfma_f32_16x16x32_bf16 v[152:155], v[182:185], v[208:211], v[152:155]
  ds_read_b64 v[218:219], v141 offset:960
  v_mfma_f32_16x16x32_bf16 v[148:151], v[184:187], v[208:211], v[148:151]
  ds_read_b64 v[200:201], v140 offset:928
  v_mfma_f32_16x16x32_bf16 v[144:147], v[186:189], v[208:211], v[144:147]
  ds_read_b64 v[202:203], v140 offset:960
  s_waitcnt lgkmcnt(4)
  v_mfma_f32_16x16x32_bf16 v[144:147], v[196:199], v[212:215], v[144:147]
  ds_read_b64 v[204:205], v141 offset:720
  ds_read_b64 v[206:207], v141 offset:752
  v_mfma_f32_16x16x32_bf16 v[148:151], v[194:197], v[212:215], v[148:151]
  ds_read_b64 v[182:183], v140 offset:736
  v_mfma_f32_16x16x32_bf16 v[152:155], v[192:195], v[212:215], v[152:155]
  ds_read_b64 v[184:185], v140 offset:768
  ds_read_b64 v[180:181], v140 offset:704
  v_mfma_f32_16x16x32_bf16 v[156:159], v[190:193], v[212:215], v[156:159]
  ds_read_b64 v[178:179], v140 offset:672
  s_waitcnt lgkmcnt(6)
  v_mfma_f32_16x16x32_bf16 v[156:159], v[194:197], v[216:219], v[156:159]
  ds_read_b64 v[176:177], v140 offset:640
  ds_read_b64 v[208:209], v141 offset:784
  v_mfma_f32_16x16x32_bf16 v[152:155], v[196:199], v[216:219], v[152:155]
  ds_read_b64 v[210:211], v141 offset:816
  v_mfma_f32_16x16x32_bf16 v[148:151], v[198:201], v[216:219], v[148:151]
  ds_read_b64 v[186:187], v140 offset:800
  v_mfma_f32_16x16x32_bf16 v[144:147], v[200:203], v[216:219], v[144:147]
  ds_read_b64 v[188:189], v140 offset:832
  s_waitcnt lgkmcnt(4)
  v_mfma_f32_16x16x32_bf16 v[144:147], v[182:185], v[204:207], v[144:147]
  ds_read_b64 v[212:213], v141 offset:576
  ds_read_b64 v[214:215], v141 offset:608
  v_mfma_f32_16x16x32_bf16 v[148:151], v[180:183], v[204:207], v[148:151]
  ds_read_b64 v[196:197], v140 offset:608
  v_mfma_f32_16x16x32_bf16 v[152:155], v[178:181], v[204:207], v[152:155]
  ds_read_b64 v[198:199], v140 offset:640
  ds_read_b64 v[194:195], v140 offset:576
  v_mfma_f32_16x16x32_bf16 v[156:159], v[176:179], v[204:207], v[156:159]
  ds_read_b64 v[192:193], v140 offset:544
  s_waitcnt lgkmcnt(6)
  v_mfma_f32_16x16x32_bf16 v[156:159], v[180:183], v[208:211], v[156:159]
  ds_read_b64 v[190:191], v140 offset:512
  ds_read_b64 v[216:217], v141 offset:640
  v_mfma_f32_16x16x32_bf16 v[152:155], v[182:185], v[208:211], v[152:155]
  ds_read_b64 v[218:219], v141 offset:672
  v_mfma_f32_16x16x32_bf16 v[148:151], v[184:187], v[208:211], v[148:151]
  ds_read_b64 v[200:201], v140 offset:672
  v_mfma_f32_16x16x32_bf16 v[144:147], v[186:189], v[208:211], v[144:147]
  ds_read_b64 v[202:203], v140 offset:704
  buffer_load_dwordx2 v[58:59], v60, s[52:55], 0 offen sc1
  s_waitcnt lgkmcnt(4)
  v_mfma_f32_16x16x32_bf16 v[144:147], v[196:199], v[212:215], v[144:147]
  ds_read_b64 v[204:205], v141 offset:432
  ds_read_b64 v[206:207], v141 offset:464
  v_mfma_f32_16x16x32_bf16 v[148:151], v[194:197], v[212:215], v[148:151]
  ds_read_b64 v[182:183], v140 offset:480
  v_mfma_f32_16x16x32_bf16 v[152:155], v[192:195], v[212:215], v[152:155]
  ds_read_b64 v[184:185], v140 offset:512
  ds_read_b64 v[180:181], v140 offset:448
  v_mfma_f32_16x16x32_bf16 v[156:159], v[190:193], v[212:215], v[156:159]
  ds_read_b64 v[178:179], v140 offset:416
  s_waitcnt lgkmcnt(6)
  v_mfma_f32_16x16x32_bf16 v[156:159], v[194:197], v[216:219], v[156:159]
  ds_read_b64 v[176:177], v140 offset:384
  ds_read_b64 v[208:209], v141 offset:496
  v_mfma_f32_16x16x32_bf16 v[152:155], v[196:199], v[216:219], v[152:155]
  ds_read_b64 v[210:211], v141 offset:528
  v_mfma_f32_16x16x32_bf16 v[148:151], v[198:201], v[216:219], v[148:151]
  ds_read_b64 v[186:187], v140 offset:544
  v_mfma_f32_16x16x32_bf16 v[144:147], v[200:203], v[216:219], v[144:147]
  ds_read_b64 v[188:189], v140 offset:576
  s_waitcnt lgkmcnt(4)
  v_mfma_f32_16x16x32_bf16 v[144:147], v[182:185], v[204:207], v[144:147]
  ds_read_b64 v[212:213], v141 offset:288
  ds_read_b64 v[214:215], v141 offset:320
  v_mfma_f32_16x16x32_bf16 v[148:151], v[180:183], v[204:207], v[148:151]
  ds_read_b64 v[196:197], v140 offset:352
  v_mfma_f32_16x16x32_bf16 v[152:155], v[178:181], v[204:207], v[152:155]
  ds_read_b64 v[198:199], v140 offset:384
  ds_read_b64 v[194:195], v140 offset:320
  v_mfma_f32_16x16x32_bf16 v[156:159], v[176:179], v[204:207], v[156:159]
  ds_read_b64 v[192:193], v140 offset:288
  s_waitcnt lgkmcnt(6)
  v_mfma_f32_16x16x32_bf16 v[156:159], v[180:183], v[208:211], v[156:159]
  ds_read_b64 v[190:191], v140 offset:256
  ds_read_b64 v[216:217], v141 offset:352
  v_mfma_f32_16x16x32_bf16 v[152:155], v[182:185], v[208:211], v[152:155]
  ds_read_b64 v[218:219], v141 offset:384
  v_mfma_f32_16x16x32_bf16 v[148:151], v[184:187], v[208:211], v[148:151]
  ds_read_b64 v[200:201], v140 offset:416
  v_mfma_f32_16x16x32_bf16 v[144:147], v[186:189], v[208:211], v[144:147]
  ds_read_b64 v[202:203], v140 offset:448
  s_waitcnt lgkmcnt(4)
  v_mfma_f32_16x16x32_bf16 v[144:147], v[196:199], v[212:215], v[144:147]
  ds_read_b64 v[204:205], v141 offset:144
  ds_read_b64 v[206:207], v141 offset:176
  v_mfma_f32_16x16x32_bf16 v[148:151], v[194:197], v[212:215], v[148:151]
  ds_read_b64 v[182:183], v140 offset:224
  v_mfma_f32_16x16x32_bf16 v[152:155], v[192:195], v[212:215], v[152:155]
  ds_read_b64 v[184:185], v140 offset:256
  ds_read_b64 v[180:181], v140 offset:192
  v_mfma_f32_16x16x32_bf16 v[156:159], v[190:193], v[212:215], v[156:159]
  ds_read_b64 v[178:179], v140 offset:160
  s_waitcnt lgkmcnt(6)
  v_mfma_f32_16x16x32_bf16 v[156:159], v[194:197], v[216:219], v[156:159]
  ds_read_b64 v[176:177], v140 offset:128
  ds_read_b64 v[208:209], v141 offset:208
  v_mfma_f32_16x16x32_bf16 v[152:155], v[196:199], v[216:219], v[152:155]
  ds_read_b64 v[210:211], v141 offset:240
  v_mfma_f32_16x16x32_bf16 v[148:151], v[198:201], v[216:219], v[148:151]
  ds_read_b64 v[186:187], v140 offset:288
  v_mfma_f32_16x16x32_bf16 v[144:147], v[200:203], v[216:219], v[144:147]
  ds_read_b64 v[188:189], v140 offset:320
  s_waitcnt lgkmcnt(4)
  v_mfma_f32_16x16x32_bf16 v[144:147], v[182:185], v[204:207], v[144:147]
  ds_read_b64 v[212:213], v141 offset:0
  ds_read_b64 v[214:215], v141 offset:32
  v_mfma_f32_16x16x32_bf16 v[148:151], v[180:183], v[204:207], v[148:151]
  ds_read_b64 v[196:197], v140 offset:96
  v_mfma_f32_16x16x32_bf16 v[152:155], v[178:181], v[204:207], v[152:155]
  ds_read_b64 v[198:199], v140 offset:128
  ds_read_b64 v[194:195], v140 offset:64
  v_mfma_f32_16x16x32_bf16 v[156:159], v[176:179], v[204:207], v[156:159]
  ds_read_b64 v[192:193], v140 offset:32
  s_waitcnt lgkmcnt(6)
  v_mfma_f32_16x16x32_bf16 v[156:159], v[180:183], v[208:211], v[156:159]
  ds_read_b64 v[190:191], v140 offset:0
  ds_read_b64 v[216:217], v141 offset:64
  v_mfma_f32_16x16x32_bf16 v[152:155], v[182:185], v[208:211], v[152:155]
  ds_read_b64 v[218:219], v141 offset:96
  v_mfma_f32_16x16x32_bf16 v[148:151], v[184:187], v[208:211], v[148:151]
  ds_read_b64 v[200:201], v140 offset:160
  v_mfma_f32_16x16x32_bf16 v[144:147], v[186:189], v[208:211], v[144:147]
  ds_read_b64 v[202:203], v140 offset:192
  s_waitcnt lgkmcnt(0)
  v_mfma_f32_16x16x32_bf16 v[144:147], v[196:199], v[212:215], v[144:147]
  v_mfma_f32_16x16x32_bf16 v[148:151], v[194:197], v[212:215], v[148:151]
  v_mfma_f32_16x16x32_bf16 v[152:155], v[192:195], v[212:215], v[152:155]
  v_mfma_f32_16x16x32_bf16 v[156:159], v[190:193], v[212:215], v[156:159]
  v_mfma_f32_16x16x32_bf16 v[156:159], v[194:197], v[216:219], v[156:159]
  v_mfma_f32_16x16x32_bf16 v[152:155], v[196:199], v[216:219], v[152:155]
  v_mfma_f32_16x16x32_bf16 v[148:151], v[198:201], v[216:219], v[148:151]
  v_mfma_f32_16x16x32_bf16 v[144:147], v[200:203], v[216:219], v[144:147]
  s_nop 3
  s_mul_i32 s70, s67, 20480
  s_lshl_b32 s71, s12, 12
  s_add_u32 s70, s70, s71
  s_add_u32 s70, s70, 120832
  v_add_u32 v42, s70, v50
  ds_write_b128 v42, v[144:147] offset:0
  v_xor_b32 v43, 64, v42
  ds_write_b128 v43, v[148:151] offset:1024
  v_xor_b32 v43, 128, v42
  ds_write_b128 v43, v[152:155] offset:2048
  v_xor_b32 v43, 192, v42
  ds_write_b128 v43, v[156:159] offset:3072
  s_cmp_ge_u32 s60, 4
  s_cbranch_scc1 F_young_42
  v_add_u32 v43, 16, v46
  s_mov_b32 s72, 0
F_cw_43:
  ds_read_b32 v42, v43 offset:20
  s_add_u32 s72, s72, 1
  s_waitcnt lgkmcnt(0)
  v_cmp_le_u32 vcc, 4, v42
  s_cmp_lt_u32 s72, 262144
  s_cbranch_vccnz F_cwok_44
  s_cbranch_scc1 F_cw_43
F_cwok_44:
  s_waitcnt vmcnt(0)
  v_cmp_ne_u64 vcc, v[58:59], v[56:57]
  s_cbranch_vccnz F_slow_45
F_back_46:
  s_mul_i32 s8, s9, s5
  s_add_u32 s9, s9, 1
  s_add_u32 s8, s8, s6
  s_cmp_eq_u32 s9, 11
  s_cselect_b32 s9, 0, s9
  s_add_u32 s72, s8, 90112
  s_add_u32 m0, s7, 0
  s_nop 0
  buffer_load_dwordx4 v114, s[44:47], s8 offen sc1 lds
  s_add_u32 m0, s7, 1024
  s_add_u32 s8, s8, s4
  buffer_load_dwordx4 v114, s[44:47], s8 offen sc1 lds
  s_add_u32 m0, s7, 2048
  s_add_u32 s8, s8, s4
  buffer_load_dwordx4 v114, s[44:47], s8 offen sc1 lds
  s_add_u32 m0, s7, 3072
  s_add_u32 s8, s8, s4
  buffer_load_dwordx4 v114, s[44:47], s8 offen sc1 lds
  s_mov_b32 s8, s72
  s_add_u32 m0, s7, 16384
  s_nop 0
  buffer_load_dwordx4 v114, s[44:47], s8 offen sc1 lds
  s_add_u32 m0, s7, 17408
  s_add_u32 s8, s8, s4
  buffer_load_dwordx4 v114, s[44:47], s8 offen sc1 lds
  s_add_u32 m0, s7, 18432
  s_add_u32 s8, s8, s4
  buffer_load_dwordx4 v114, s[44:47], s8 offen sc1 lds
  s_add_u32 m0, s7, 19456
  s_add_u32 s8, s8, s4
  buffer_load_dwordx4 v114, s[44:47], s8 offen sc1 lds
  s_mul_i32 s8, s9, s5
  s_add_u32 s9, s9, 1
  s_add_u32 s8, s8, s6
  s_cmp_eq_u32 s9, 11
  s_cselect_b32 s9, 0, s9
  s_add_u32 s72, s8, 90112
  s_add_u32 m0, s7, 32768
  s_nop 0
  buffer_load_dwordx4 v114, s[44:47], s8 offen sc1 lds
  s_add_u32 m0, s7, 33792
  s_add_u32 s8, s8, s4
  buffer_load_dwordx4 v114, s[44:47], s8 offen sc1 lds
  s_add_u32 m0, s7, 34816
  s_add_u32 s8, s8, s4
  buffer_load_dwordx4 v114, s[44:47], s8 offen sc1 lds
  s_add_u32 m0, s7, 35840
  s_add_u32 s8, s8, s4
  buffer_load_dwordx4 v114, s[44:47], s8 offen sc1 lds
  s_mov_b32 s8, s72
  s_add_u32 m0, s7, 49152
  s_nop 0
  buffer_load_dwordx4 v114, s[44:47], s8 offen sc1 lds
  s_add_u32 m0, s7, 50176
  s_add_u32 s8, s8, s4
  buffer_load_dwordx4 v114, s[44:47], s8 offen sc1 lds
  s_add_u32 m0, s7, 51200
  s_add_u32 s8, s8, s4
  buffer_load_dwordx4 v114, s[44:47], s8 offen sc1 lds
  s_add_u32 m0, s7, 52224
  s_add_u32 s8, s8, s4
  buffer_load_dwordx4 v114, s[44:47], s8 offen sc1 lds
  s_branch F_young_42_j
F_young_42:
  s_add_u32 s9, s9, 2
  s_cmp_ge_u32 s9, 11
  s_cselect_b32 s70, 11, 0
  s_sub_u32 s9, s9, s70
F_young_42_j:
  s_branch F_cdone_38
F_p2_36:
  s_mov_b32 s10, 1
  s_mov_b32 s11, 31
  s_lshl_b32 s70, s11, 7
  s_add_u32 s70, s70, 96
  v_subrev_u32 v140, s70, v99
  s_lshl_b32 s70, s10, 4
  s_sub_u32 s70, s70, s11
  s_mul_i32 s70, s70, 144
  v_add_u32 v141, s70, v100
  v_subrev_u32 v142, 480, v99
  v_subrev_u32 v143, 432, v100
  ds_read_b64 v[204:205], v141 offset:1008
  ds_read_b64 v[206:207], v141 offset:1040
  ds_read_b64 v[182:183], v140 offset:992
  ds_read_b64 v[184:185], v140 offset:1024
  ds_read_b64 v[180:181], v140 offset:960
  ds_read_b64 v[178:179], v140 offset:928
  ds_read_b64 v[176:177], v140 offset:896
  ds_read_b64 v[208:209], v141 offset:1072
  ds_read_b64 v[210:211], v141 offset:1104
  ds_read_b64 v[186:187], v140 offset:1056
  ds_read_b64 v[188:189], v140 offset:1088
  s_waitcnt lgkmcnt(4)
  v_mfma_f32_16x16x32_bf16 v[144:147], v[182:185], v[204:207], 0
  ds_read_b64 v[212:213], v141 offset:864
  ds_read_b64 v[214:215], v141 offset:896
  v_mfma_f32_16x16x32_bf16 v[148:151], v[180:183], v[204:207], 0
  ds_read_b64 v[196:197], v140 offset:864
  v_mfma_f32_16x16x32_bf16 v[152:155], v[178:181], v[204:207], 0
  ds_read_b64 v[198:199], v140 offset:896
  ds_read_b64 v[194:195], v140 offset:832
  v_mfma_f32_16x16x32_bf16 v[156:159], v[176:179], v[204:207], 0
  ds_read_b64 v[192:193], v140 offset:800
  s_waitcnt lgkmcnt(6)
  v_mfma_f32_16x16x32_bf16 v[156:159], v[180:183], v[208:211], v[156:159]
  ds_read_b64 v[190:191], v140 offset:768
  ds_read_b64 v[216:217], v141 offset:928
  v_mfma_f32_16x16x32_bf16 v[152:155], v[182:185], v[208:211], v[152:155]
  ds_read_b64 v[218:219], v141 offset:960
  v_mfma_f32_16x16x32_bf16 v[148:151], v[184:187], v[208:211], v[148:151]
  ds_read_b64 v[200:201], v140 offset:928
  v_mfma_f32_16x16x32_bf16 v[144:147], v[186:189], v[208:211], v[144:147]
  ds_read_b64 v[202:203], v140 offset:960
  s_waitcnt lgkmcnt(4)
  v_mfma_f32_16x16x32_bf16 v[144:147], v[196:199], v[212:215], v[144:147]
  ds_read_b64 v[204:205], v141 offset:720
  ds_read_b64 v[206:207], v141 offset:752
  v_mfma_f32_16x16x32_bf16 v[148:151], v[194:197], v[212:215], v[148:151]
  ds_read_b64 v[182:183], v140 offset:736
  v_mfma_f32_16x16x32_bf16 v[152:155], v[192:195], v[212:215], v[152:155]
  ds_read_b64 v[184:185], v140 offset:768
  ds_read_b64 v[180:181], v140 offset:704
  v_mfma_f32_16x16x32_bf16 v[156:159], v[190:193], v[212:215], v[156:159]
  ds_read_b64 v[178:179], v140 offset:672
  s_waitcnt lgkmcnt(6)
  v_mfma_f32_16x16x32_bf16 v[156:159], v[194:197], v[216:219], v[156:159]
  ds_read_b64 v[176:177], v140 offset:640
  ds_read_b64 v[208:209], v141 offset:784
  v_mfma_f32_16x16x32_bf16 v[152:155], v[196:199], v[216:219], v[152:155]
  ds_read_b64 v[210:211], v141 offset:816
  v_mfma_f32_16x16x32_bf16 v[148:151], v[198:201], v[216:219], v[148:151]
  ds_read_b64 v[186:187], v140 offset:800
  v_mfma_f32_16x16x32_bf16 v[144:147], v[200:203], v[216:219], v[144:147]
  ds_read_b64 v[188:189], v140 offset:832
  s_waitcnt lgkmcnt(4)
  v_mfma_f32_16x16x32_bf16 v[144:147], v[182:185], v[204:207], v[144:147]
  ds_read_b64 v[212:213], v141 offset:576
  ds_read_b64 v[214:215], v141 offset:608
  v_mfma_f32_16x16x32_bf16 v[148:151], v[180:183], v[204:207], v[148:151]
  ds_read_b64 v[196:197], v140 offset:608
  v_mfma_f32_16x16x32_bf16 v[152:155], v[178:181], v[204:207], v[152:155]
  ds_read_b64 v[198:199], v140 offset:640
  ds_read_b64 v[194:195], v140 offset:576
  v_mfma_f32_16x16x32_bf16 v[156:159], v[176:179], v[204:207], v[156:159]
  ds_read_b64 v[192:193], v140 offset:544
  s_waitcnt lgkmcnt(6)
  v_mfma_f32_16x16x32_bf16 v[156:159], v[180:183], v[208:211], v[156:159]
  ds_read_b64 v[190:191], v140 offset:512
  ds_read_b64 v[216:217], v141 offset:640
  v_mfma_f32_16x16x32_bf16 v[152:155], v[182:185], v[208:211], v[152:155]
  ds_read_b64 v[218:219], v141 offset:672
  v_mfma_f32_16x16x32_bf16 v[148:151], v[184:187], v[208:211], v[148:151]
  ds_read_b64 v[200:201], v140 offset:672
  v_mfma_f32_16x16x32_bf16 v[144:147], v[186:189], v[208:211], v[144:147]
  ds_read_b64 v[202:203], v140 offset:704
  s_waitcnt lgkmcnt(4)
  v_mfma_f32_16x16x32_bf16 v[144:147], v[196:199], v[212:215], v[144:147]
  ds_read_b64 v[204:205], v141 offset:432
  ds_read_b64 v[206:207], v141 offset:464
  v_mfma_f32_16x16x32_bf16 v[148:151], v[194:197], v[212:215], v[148:151]
  ds_read_b64 v[182:183], v140 offset:480
  v_mfma_f32_16x16x32_bf16 v[152:155], v[192:195], v[212:215], v[152:155]
  ds_read_b64 v[184:185], v140 offset:512
  ds_read_b64 v[180:181], v140 offset:448
  v_mfma_f32_16x16x32_bf16 v[156:159], v[190:193], v[212:215], v[156:159]
  ds_read_b64 v[178:179], v140 offset:416
  s_waitcnt lgkmcnt(6)
  v_mfma_f32_16x16x32_bf16 v[156:159], v[194:197], v[216:219], v[156:159]
  ds_read_b64 v[176:177], v140 offset:384
  ds_read_b64 v[208:209], v141 offset:496
  v_mfma_f32_16x16x32_bf16 v[152:155], v[196:199], v[216:219], v[152:155]
  ds_read_b64 v[210:211], v141 offset:528
  v_mfma_f32_16x16x32_bf16 v[148:151], v[198:201], v[216:219], v[148:151]
  ds_read_b64 v[186:187], v140 offset:544
  v_mfma_f32_16x16x32_bf16 v[144:147], v[200:203], v[216:219], v[144:147]
  ds_read_b64 v[188:189], v140 offset:576
  s_waitcnt lgkmcnt(4)
  v_mfma_f32_16x16x32_bf16 v[144:147], v[182:185], v[204:207], v[144:147]
  ds_read_b64 v[212:213], v141 offset:288
  ds_read_b64 v[214:215], v141 offset:320
  v_mfma_f32_16x16x32_bf16 v[148:151], v[180:183], v[204:207], v[148:151]
  ds_read_b64 v[196:197], v140 offset:352
  v_mfma_f32_16x16x32_bf16 v[152:155], v[178:181], v[204:207], v[152:155]
  ds_read_b64 v[198:199], v140 offset:384
  ds_read_b64 v[194:195], v140 offset:320
  v_mfma_f32_16x16x32_bf16 v[156:159], v[176:179], v[204:207], v[156:159]
  ds_read_b64 v[192:193], v140 offset:288
  s_waitcnt lgkmcnt(6)
  v_mfma_f32_16x16x32_bf16 v[156:159], v[180:183], v[208:211], v[156:159]
  ds_read_b64 v[190:191], v140 offset:256
  ds_read_b64 v[216:217], v141 offset:352
  v_mfma_f32_16x16x32_bf16 v[152:155], v[182:185], v[208:211], v[152:155]
  ds_read_b64 v[218:219], v141 offset:384
  v_mfma_f32_16x16x32_bf16 v[148:151], v[184:187], v[208:211], v[148:151]
  ds_read_b64 v[200:201], v140 offset:416
  v_mfma_f32_16x16x32_bf16 v[144:147], v[186:189], v[208:211], v[144:147]
  ds_read_b64 v[202:203], v140 offset:448
  s_waitcnt lgkmcnt(4)
  v_mfma_f32_16x16x32_bf16 v[144:147], v[196:199], v[212:215], v[144:147]
  ds_read_b64 v[204:205], v141 offset:144
  ds_read_b64 v[206:207], v141 offset:176
  v_mfma_f32_16x16x32_bf16 v[148:151], v[194:197], v[212:215], v[148:151]
  ds_read_b64 v[182:183], v140 offset:224
  v_mfma_f32_16x16x32_bf16 v[152:155], v[192:195], v[212:215], v[152:155]
  ds_read_b64 v[184:185], v140 offset:256
  ds_read_b64 v[180:181], v140 offset:192
  v_mfma_f32_16x16x32_bf16 v[156:159], v[190:193], v[212:215], v[156:159]
  ds_read_b64 v[178:179], v140 offset:160
  s_waitcnt lgkmcnt(6)
  v_mfma_f32_16x16x32_bf16 v[156:159], v[194:197], v[216:219], v[156:159]
  ds_read_b64 v[176:177], v140 offset:128
  ds_read_b64 v[208:209], v141 offset:208
  v_mfma_f32_16x16x32_bf16 v[152:155], v[196:199], v[216:219], v[152:155]
  ds_read_b64 v[210:211], v141 offset:240
  v_mfma_f32_16x16x32_bf16 v[148:151], v[198:201], v[216:219], v[148:151]
  ds_read_b64 v[186:187], v140 offset:288
  v_mfma_f32_16x16x32_bf16 v[144:147], v[200:203], v[216:219], v[144:147]
  ds_read_b64 v[188:189], v140 offset:320
  s_waitcnt lgkmcnt(4)
  v_mfma_f32_16x16x32_bf16 v[144:147], v[182:185], v[204:207], v[144:147]
  ds_read_b64 v[212:213], v141 offset:0
  ds_read_b64 v[214:215], v141 offset:32
  v_mfma_f32_16x16x32_bf16 v[148:151], v[180:183], v[204:207], v[148:151]
  ds_read_b64 v[196:197], v140 offset:96
  v_mfma_f32_16x16x32_bf16 v[152:155], v[178:181], v[204:207], v[152:155]
  ds_read_b64 v[198:199], v140 offset:128
  ds_read_b64 v[194:195], v140 offset:64
  v_mfma_f32_16x16x32_bf16 v[156:159], v[176:179], v[204:207], v[156:159]
  ds_read_b64 v[192:193], v140 offset:32
  s_waitcnt lgkmcnt(6)
  v_mfma_f32_16x16x32_bf16 v[156:159], v[180:183], v[208:211], v[156:159]
  ds_read_b64 v[190:191], v140 offset:0
  ds_read_b64 v[216:217], v141 offset:64
  v_mfma_f32_16x16x32_bf16 v[152:155], v[182:185], v[208:211], v[152:155]
  ds_read_b64 v[218:219], v141 offset:96
  v_mfma_f32_16x16x32_bf16 v[148:151], v[184:187], v[208:211], v[148:151]
  ds_read_b64 v[200:201], v140 offset:160
  v_mfma_f32_16x16x32_bf16 v[144:147], v[186:189], v[208:211], v[144:147]
  ds_read_b64 v[202:203], v140 offset:192
  buffer_load_dwordx2 v[58:59], v60, s[52:55], 0 offen sc1
  s_waitcnt lgkmcnt(4)
  v_mfma_f32_16x16x32_bf16 v[144:147], v[196:199], v[212:215], v[144:147]
  ds_read_b64 v[204:205], v143 offset:432
  ds_read_b64 v[206:207], v143 offset:464
  v_mfma_f32_16x16x32_bf16 v[148:151], v[194:197], v[212:215], v[148:151]
  ds_read_b64 v[182:183], v142 offset:480
  v_mfma_f32_16x16x32_bf16 v[152:155], v[192:195], v[212:215], v[152:155]
  ds_read_b64 v[184:185], v142 offset:512
  ds_read_b64 v[180:181], v142 offset:448
  v_mfma_f32_16x16x32_bf16 v[156:159], v[190:193], v[212:215], v[156:159]
  ds_read_b64 v[178:179], v142 offset:416
  s_waitcnt lgkmcnt(6)
  v_mfma_f32_16x16x32_bf16 v[156:159], v[194:197], v[216:219], v[156:159]
  ds_read_b64 v[176:177], v142 offset:384
  ds_read_b64 v[208:209], v143 offset:496
  v_mfma_f32_16x16x32_bf16 v[152:155], v[196:199], v[216:219], v[152:155]
  ds_read_b64 v[210:211], v143 offset:528
  v_mfma_f32_16x16x32_bf16 v[148:151], v[198:201], v[216:219], v[148:151]
  ds_read_b64 v[186:187], v142 offset:544
  v_mfma_f32_16x16x32_bf16 v[144:147], v[200:203], v[216:219], v[144:147]
  ds_read_b64 v[188:189], v142 offset:576
  s_waitcnt lgkmcnt(4)
  v_mfma_f32_16x16x32_bf16 v[160:163], v[182:185], v[204:207], 0
  ds_read_b64 v[212:213], v143 offset:288
  ds_read_b64 v[214:215], v143 offset:320
  v_mfma_f32_16x16x32_bf16 v[164:167], v[180:183], v[204:207], 0
  ds_read_b64 v[196:197], v142 offset:352
  v_mfma_f32_16x16x32_bf16 v[168:171], v[178:181], v[204:207], 0
  ds_read_b64 v[198:199], v142 offset:384
  ds_read_b64 v[194:195], v142 offset:320
  v_mfma_f32_16x16x32_bf16 v[172:175], v[176:179], v[204:207], 0
  ds_read_b64 v[192:193], v142 offset:288
  s_waitcnt lgkmcnt(6)
  v_mfma_f32_16x16x32_bf16 v[172:175], v[180:183], v[208:211], v[172:175]
  ds_read_b64 v[190:191], v142 offset:256
  ds_read_b64 v[216:217], v143 offset:352
  v_mfma_f32_16x16x32_bf16 v[168:171], v[182:185], v[208:211], v[168:171]
  ds_read_b64 v[218:219], v143 offset:384
  v_mfma_f32_16x16x32_bf16 v[164:167], v[184:187], v[208:211], v[164:167]
  ds_read_b64 v[200:201], v142 offset:416
  v_mfma_f32_16x16x32_bf16 v[160:163], v[186:189], v[208:211], v[160:163]
  ds_read_b64 v[202:203], v142 offset:448
  s_waitcnt lgkmcnt(4)
  v_mfma_f32_16x16x32_bf16 v[160:163], v[196:199], v[212:215], v[160:163]
  ds_read_b64 v[204:205], v143 offset:144
  ds_read_b64 v[206:207], v143 offset:176
  v_mfma_f32_16x16x32_bf16 v[164:167], v[194:197], v[212:215], v[164:167]
  ds_read_b64 v[182:183], v142 offset:224
  v_mfma_f32_16x16x32_bf16 v[168:171], v[192:195], v[212:215], v[168:171]
  ds_read_b64 v[184:185], v142 offset:256
  ds_read_b64 v[180:181], v142 offset:192
  v_mfma_f32_16x16x32_bf16 v[172:175], v[190:193], v[212:215], v[172:175]
  ds_read_b64 v[178:179], v142 offset:160
  s_waitcnt lgkmcnt(6)
  v_mfma_f32_16x16x32_bf16 v[172:175], v[194:197], v[216:219], v[172:175]
  ds_read_b64 v[176:177], v142 offset:128
  ds_read_b64 v[208:209], v143 offset:208
  v_mfma_f32_16x16x32_bf16 v[168:171], v[196:199], v[216:219], v[168:171]
  ds_read_b64 v[210:211], v143 offset:240
  v_mfma_f32_16x16x32_bf16 v[164:167], v[198:201], v[216:219], v[164:167]
  ds_read_b64 v[186:187], v142 offset:288
  v_mfma_f32_16x16x32_bf16 v[160:163], v[200:203], v[216:219], v[160:163]
  ds_read_b64 v[188:189], v142 offset:320
  s_waitcnt lgkmcnt(4)
  v_mfma_f32_16x16x32_bf16 v[160:163], v[182:185], v[204:207], v[160:163]
  ds_read_b64 v[212:213], v143 offset:0
  ds_read_b64 v[214:215], v143 offset:32
  v_mfma_f32_16x16x32_bf16 v[164:167], v[180:183], v[204:207], v[164:167]
  ds_read_b64 v[196:197], v142 offset:96
  v_mfma_f32_16x16x32_bf16 v[168:171], v[178:181], v[204:207], v[168:171]
  ds_read_b64 v[198:199], v142 offset:128
  ds_read_b64 v[194:195], v142 offset:64
  v_mfma_f32_16x16x32_bf16 v[172:175], v[176:179], v[204:207], v[172:175]
  ds_read_b64 v[192:193], v142 offset:32
  s_waitcnt lgkmcnt(6)
  v_mfma_f32_16x16x32_bf16 v[172:175], v[180:183], v[208:211], v[172:175]
  ds_read_b64 v[190:191], v142 offset:0
  ds_read_b64 v[216:217], v143 offset:64
  v_mfma_f32_16x16x32_bf16 v[168:171], v[182:185], v[208:211], v[168:171]
  ds_read_b64 v[218:219], v143 offset:96
  v_mfma_f32_16x16x32_bf16 v[164:167], v[184:187], v[208:211], v[164:167]
  ds_read_b64 v[200:201], v142 offset:160
  v_mfma_f32_16x16x32_bf16 v[160:163], v[186:189], v[208:211], v[160:163]
  ds_read_b64 v[202:203], v142 offset:192
  s_waitcnt lgkmcnt(0)
  v_mfma_f32_16x16x32_bf16 v[160:163], v[196:199], v[212:215], v[160:163]
  v_mfma_f32_16x16x32_bf16 v[164:167], v[194:197], v[212:215], v[164:167]
  v_mfma_f32_16x16x32_bf16 v[168:171], v[192:195], v[212:215], v[168:171]
  v_mfma_f32_16x16x32_bf16 v[172:175], v[190:193], v[212:215], v[172:175]
  v_mfma_f32_16x16x32_bf16 v[172:175], v[194:197], v[216:219], v[172:175]
  v_mfma_f32_16x16x32_bf16 v[168:171], v[196:199], v[216:219], v[168:171]
  v_mfma_f32_16x16x32_bf16 v[164:167], v[198:201], v[216:219], v[164:167]
  v_mfma_f32_16x16x32_bf16 v[160:163], v[200:203], v[216:219], v[160:163]
  s_mov_b32 s12, 2
  s_nop 2
  s_mul_i32 s70, s67, 20480
  s_lshl_b32 s71, s12, 12
  s_add_u32 s70, s70, s71
  s_add_u32 s70, s70, 120832
  v_add_u32 v42, s70, v50
  ds_write_b128 v42, v[144:147] offset:0
  v_xor_b32 v43, 64, v42
  ds_write_b128 v43, v[148:151] offset:1024
  v_xor_b32 v43, 128, v42
  ds_write_b128 v43, v[152:155] offset:2048
  v_xor_b32 v43, 192, v42
  ds_write_b128 v43, v[156:159] offset:3072
  v_add_u32 v42, 4096, v42
  ds_write_b128 v42, v[160:163] offset:0
  v_xor_b32 v43, 64, v42
  ds_write_b128 v43, v[164:167] offset:1024
  v_xor_b32 v43, 128, v42
  ds_write_b128 v43, v[168:171] offset:2048
  v_xor_b32 v43, 192, v42
  ds_write_b128 v43, v[172:175] offset:3072
  s_cmp_ge_u32 s60, 4
  s_cbranch_scc1 F_young_47
  v_add_u32 v43, 16, v46
  s_mov_b32 s72, 0
F_cw_48:
  ds_read_b32 v42, v43 offset:20
  s_add_u32 s72, s72, 1
  s_waitcnt lgkmcnt(0)
  v_cmp_le_u32 vcc, 4, v42
  s_cmp_lt_u32 s72, 262144
  s_cbranch_vccnz F_cwok_49
  s_cbranch_scc1 F_cw_48
F_cwok_49:
  s_waitcnt vmcnt(0)
  v_cmp_ne_u64 vcc, v[58:59], v[56:57]
  s_cbranch_vccnz F_slow_50
F_back_51:
  s_mul_i32 s8, s9, s5
  s_add_u32 s9, s9, 1
  s_add_u32 s8, s8, s6
  s_cmp_eq_u32 s9, 11
  s_cselect_b32 s9, 0, s9
  s_add_u32 s72, s8, 90112
  s_add_u32 m0, s7, 0
  s_nop 0
  buffer_load_dwordx4 v114, s[44:47], s8 offen sc1 lds
  s_add_u32 m0, s7, 1024
  s_add_u32 s8, s8, s4
  buffer_load_dwordx4 v114, s[44:47], s8 offen sc1 lds
  s_add_u32 m0, s7, 2048
  s_add_u32 s8, s8, s4
  buffer_load_dwordx4 v114, s[44:47], s8 offen sc1 lds
  s_add_u32 m0, s7, 3072
  s_add_u32 s8, s8, s4
  buffer_load_dwordx4 v114, s[44:47], s8 offen sc1 lds
  s_mov_b32 s8, s72
  s_add_u32 m0, s7, 16384
  s_nop 0
  buffer_load_dwordx4 v114, s[44:47], s8 offen sc1 lds
  s_add_u32 m0, s7, 17408
  s_add_u32 s8, s8, s4
  buffer_load_dwordx4 v114, s[44:47], s8 offen sc1 lds
  s_add_u32 m0, s7, 18432
  s_add_u32 s8, s8, s4
  buffer_load_dwordx4 v114, s[44:47], s8 offen sc1 lds
  s_add_u32 m0, s7, 19456
  s_add_u32 s8, s8, s4
  buffer_load_dwordx4 v114, s[44:47], s8 offen sc1 lds
  s_mul_i32 s8, s9, s5
  s_add_u32 s9, s9, 1
  s_add_u32 s8, s8, s6
  s_cmp_eq_u32 s9, 11
  s_cselect_b32 s9, 0, s9
  s_add_u32 s72, s8, 90112
  s_add_u32 m0, s7, 32768
  s_nop 0
  buffer_load_dwordx4 v114, s[44:47], s8 offen sc1 lds
  s_add_u32 m0, s7, 33792
  s_add_u32 s8, s8, s4
  buffer_load_dwordx4 v114, s[44:47], s8 offen sc1 lds
  s_add_u32 m0, s7, 34816
  s_add_u32 s8, s8, s4
  buffer_load_dwordx4 v114, s[44:47], s8 offen sc1 lds
  s_add_u32 m0, s7, 35840
  s_add_u32 s8, s8, s4
  buffer_load_dwordx4 v114, s[44:47], s8 offen sc1 lds
  s_mov_b32 s8, s72
  s_add_u32 m0, s7, 49152
  s_nop 0
  buffer_load_dwordx4 v114, s[44:47], s8 offen sc1 lds
  s_add_u32 m0, s7, 50176
  s_add_u32 s8, s8, s4
  buffer_load_dwordx4 v114, s[44:47], s8 offen sc1 lds
  s_add_u32 m0, s7, 51200
  s_add_u32 s8, s8, s4
  buffer_load_dwordx4 v114, s[44:47], s8 offen sc1 lds
  s_add_u32 m0, s7, 52224
  s_add_u32 s8, s8, s4
  buffer_load_dwordx4 v114, s[44:47], s8 offen sc1 lds
  s_branch F_young_47_j
F_young_47:
  s_add_u32 s9, s9, 2
  s_cmp_ge_u32 s9, 11
  s_cselect_b32 s70, 11, 0
  s_sub_u32 s9, s9, s70
F_young_47_j:
F_cdone_38:
  s_waitcnt lgkmcnt(0)
  s_barrier
  s_mul_i32 s8, s9, s5
  s_add_u32 s9, s9, 1
  s_add_u32 s8, s8, s6
  s_cmp_eq_u32 s9, 11
  s_cselect_b32 s9, 0, s9
  s_add_u32 m0, s7, 65536
  s_nop 0
  buffer_load_dwordx4 v114, s[44:47], s8 offen sc1 lds
  s_add_u32 m0, s7, 66560
  s_add_u32 s8, s8, s4
  buffer_load_dwordx4 v114, s[44:47], s8 offen sc1 lds
  s_add_u32 m0, s7, 67584
  s_add_u32 s8, s8, s4
  buffer_load_dwordx4 v114, s[44:47], s8 offen sc1 lds
  s_add_u32 m0, s7, 68608
  s_add_u32 s8, s8, s4
  buffer_load_dwordx4 v114, s[44:47], s8 offen sc1 lds
  s_cmp_ge_u32 s66, 2
  s_cselect_b64 vcc, -1, 0
  ds_read_b128 v[4:7], v119 offset:0
  ds_read_b128 v[8:11], v119 offset:256
  ds_read_b128 v[12:15], v119 offset:4096
  ds_read_b128 v[16:19], v119 offset:4352
  v_add_u32 v44, 8192, v119
  v_mov_b32 v45, s85
  v_cndmask_b32 v44, v44, v45, vcc
  ds_read_b128 v[20:23], v44
  v_add_u32 v45, 256, v44
  v_cndmask_b32 v44, v45, v44, vcc
  ds_read_b128 v[24:27], v44
  ds_read_b128 v[28:31], v120
  s_lshl_b32 s70, s79, 12
  s_add_u32 s70, s70, 8388608
  s_waitcnt lgkmcnt(3)
  v_pk_add_f32 v[144:145], v[4:5], v[12:13]
  v_pk_add_f32 v[146:147], v[6:7], v[14:15]
  v_pk_add_f32 v[148:149], v[8:9], v[16:17]
  v_pk_add_f32 v[150:151], v[10:11], v[18:19]
  s_waitcnt lgkmcnt(0)
  v_lshlrev_b32 v152, 16, v28
  v_and_b32 v153, 0xffff0000, v28
  v_lshlrev_b32 v154, 16, v29
  v_and_b32 v155, 0xffff0000, v29
  v_lshlrev_b32 v156, 16, v30
  v_and_b32 v157, 0xffff0000, v30
  v_lshlrev_b32 v158, 16, v31
  v_and_b32 v159, 0xffff0000, v31
  v_pk_add_f32 v[144:145], v[144:145], v[20:21]
  v_pk_add_f32 v[146:147], v[146:147], v[22:23]
  v_pk_add_f32 v[148:149], v[148:149], v[24:25]
  v_pk_add_f32 v[150:151], v[150:151], v[26:27]
  v_mov_b32 v42, v113
  v_pk_fma_f32 v[144:145], v[152:153], v[42:43], v[144:145] op_sel_hi:[1,0,1]
  v_pk_fma_f32 v[146:147], v[154:155], v[42:43], v[146:147] op_sel_hi:[1,0,1]
  v_pk_fma_f32 v[148:149], v[156:157], v[42:43], v[148:149] op_sel_hi:[1,0,1]
  v_pk_fma_f32 v[150:151], v[158:159], v[42:43], v[150:151] op_sel_hi:[1,0,1]
  v_cvt_pk_bf16_f32 v28, v144, v145
  v_cvt_pk_bf16_f32 v29, v146, v147
  v_cvt_pk_bf16_f32 v30, v148, v149
  v_cvt_pk_bf16_f32 v31, v150, v151
  buffer_store_dwordx4 v[28:31], v121, s[52:55], s70 offen sc1
  s_lshl_b32 s14, s62, 5
  s_waitcnt vmcnt(13)
  s_barrier
  ds_read_b64_tr_b16 v[156:157], v115 offset:0
  ds_read_b64 v[164:165], v116 offset:0
  ds_read_b64_tr_b16 v[158:159], v115 offset:512
  ds_read_b64 v[166:167], v116 offset:512
  s_waitcnt vmcnt(5)
  s_barrier
  s_mul_i32 s8, s9, s5
  s_add_u32 s9, s9, 1
  s_add_u32 s8, s8, s6
  s_cmp_eq_u32 s9, 11
  s_cselect_b32 s9, 0, s9
  ds_read_b64_tr_b16 v[160:161], v115 offset:2048
  ds_read_b64 v[168:169], v116 offset:2048
  ds_read_b64_tr_b16 v[162:163], v115 offset:2560
  ds_read_b64 v[170:171], v116 offset:2560
  s_waitcnt lgkmcnt(4)
  v_mfma_f32_32x32x16_bf16 v[140:155], v[156:159], v[164:167], 0
  s_add_u32 m0, s7, 131072
  s_nop 0
  buffer_load_dwordx4 v114, s[44:47], s8 offen sc1 lds
  ds_read_b64_tr_b16 v[156:157], v115 offset:4096
  ds_read_b64 v[164:165], v116 offset:4096
  ds_read_b64_tr_b16 v[158:159], v115 offset:4608
  ds_read_b64 v[166:167], v116 offset:4608
  s_waitcnt lgkmcnt(4)
  v_mfma_f32_32x32x16_bf16 v[140:155], v[160:163], v[168:171], v[140:155]
  s_add_u32 m0, s7, 132096
  s_add_u32 s8, s8, s4
  buffer_load_dwordx4 v114, s[44:47], s8 offen sc1 lds
  s_lshl_b32 s70, s62, 7
  s_add_u32 s13, s73, s70
  ds_read_b64_tr_b16 v[160:161], v115 offset:6144
  ds_read_b64 v[168:169], v116 offset:6144
  ds_read_b64_tr_b16 v[162:163], v115 offset:6656
  ds_read_b64 v[170:171], v116 offset:6656
  s_waitcnt lgkmcnt(4)
  v_mfma_f32_32x32x16_bf16 v[140:155], v[156:159], v[164:167], v[140:155]
  s_add_u32 m0, s7, 133120
  s_add_u32 s8, s8, s4
  buffer_load_dwordx4 v114, s[44:47], s8 offen sc1 lds
  v_lshlrev_b32 v42, 12, v39
  v_lshl_add_u32 v176, v40, 4, v42
  v_add_u32 v115, 32768, v115
  v_add_u32 v116, 32768, v116
  ds_read_b64_tr_b16 v[156:157], v115 offset:0
  ds_read_b64 v[164:165], v116 offset:0
  ds_read_b64_tr_b16 v[158:159], v115 offset:512
  ds_read_b64 v[166:167], v116 offset:512
  s_waitcnt lgkmcnt(4)
  v_mfma_f32_32x32x16_bf16 v[140:155], v[160:163], v[168:171], v[140:155]
  s_add_u32 m0, s7, 134144
  s_add_u32 s8, s8, s4
  buffer_load_dwordx4 v114, s[44:47], s8 offen sc1 lds
  s_waitcnt vmcnt(5)
  s_barrier
  s_mul_i32 s8, s9, s5
  s_add_u32 s9, s9, 1
  s_add_u32 s8, s8, s6
  s_cmp_eq_u32 s9, 11
  s_cselect_b32 s9, 0, s9
  ds_read_b64_tr_b16 v[160:161], v115 offset:2048
  ds_read_b64 v[168:169], v116 offset:2048
  ds_read_b64_tr_b16 v[162:163], v115 offset:2560
  ds_read_b64 v[170:171], v116 offset:2560
  s_waitcnt lgkmcnt(4)
  v_mfma_f32_32x32x16_bf16 v[140:155], v[156:159], v[164:167], v[140:155]
  s_add_u32 m0, s7, 0
  s_nop 0
  buffer_load_dwordx4 v114, s[44:47], s8 offen sc1 lds
  ds_read_b64_tr_b16 v[156:157], v115 offset:4096
  ds_read_b64 v[164:165], v116 offset:4096
  ds_read_b64_tr_b16 v[158:159], v115 offset:4608
  ds_read_b64 v[166:167], v116 offset:4608
  s_waitcnt lgkmcnt(4)
  v_mfma_f32_32x32x16_bf16 v[140:155], v[160:163], v[168:171], v[140:155]
  s_add_u32 m0, s7, 1024
  s_add_u32 s8, s8, s4
  buffer_load_dwordx4 v114, s[44:47], s8 offen sc1 lds
  s_lshl_b32 s70, s66, 12
  s_lshl_b32 s71, s67, 11
  s_add_u32 s71, s70, s71
  s_add_u32 s71, s71, 114688
  v_lshl_add_u32 v177, v36, 4, s71
  v_xor_b32 v178, 2048, v177
  ds_read_b64_tr_b16 v[160:161], v115 offset:6144
  ds_read_b64 v[168:169], v116 offset:6144
  ds_read_b64_tr_b16 v[162:163], v115 offset:6656
  ds_read_b64 v[170:171], v116 offset:6656
  s_waitcnt lgkmcnt(4)
  v_mfma_f32_32x32x16_bf16 v[140:155], v[156:159], v[164:167], v[140:155]
  s_add_u32 m0, s7, 2048
  s_add_u32 s8, s8, s4
  buffer_load_dwordx4 v114, s[44:47], s8 offen sc1 lds
  v_lshrrev_b32 v42, 1, v38
  v_lshlrev_b32 v42, 2, v42
  v_lshrrev_b32 v43, 2, v37
  v_add_u32 v42, v42, v43
  s_lshl_b32 s70, s69, 5
  s_lshl_b32 s71, s67, 4
  s_add_u32 s70, s70, s71
  v_add_u32 v42, s70, v42
  v_lshlrev_b32 v42, 7, v42
  v_add_u32 v115, 32768, v115
  v_add_u32 v116, 32768, v116
  ds_read_b64_tr_b16 v[156:157], v115 offset:0
  ds_read_b64 v[164:165], v116 offset:0
  ds_read_b64_tr_b16 v[158:159], v115 offset:512
  ds_read_b64 v[166:167], v116 offset:512
  s_waitcnt lgkmcnt(4)
  v_mfma_f32_32x32x16_bf16 v[140:155], v[160:163], v[168:171], v[140:155]
  s_add_u32 m0, s7, 3072
  s_add_u32 s8, s8, s4
  buffer_load_dwordx4 v114, s[44:47], s8 offen sc1 lds
  s_waitcnt vmcnt(4)
  s_barrier
  s_lshl_b32 s70, s2, 7
  s_add_u32 s70, s70, 12648448
  s_cmp_eq_u32 s60, 0
  s_cselect_b32 s70, s70, 1073741824
  v_mov_b32 v45, s70
  s_mov_b64 exec, 1
  buffer_store_dwordx2 v[56:57], v45, s[52:55], 0 offen sc1
  s_mov_b64 exec, -1
  v_min_u32 v60, 31, v36
  s_lshl_b32 s70, s14, 7
  s_add_u32 s70, s70, 12648448
  v_lshl_add_u32 v60, v60, 7, s70
  s_cmp_eq_u32 s60, 0
  s_cselect_b32 s70, 0, 1073741824
  v_add_u32 v60, s70, v60
  s_mul_i32 s8, s9, s5
  s_add_u32 s9, s9, 1
  s_add_u32 s8, s8, s6
  s_cmp_eq_u32 s9, 11
  s_cselect_b32 s9, 0, s9
  ds_read_b64_tr_b16 v[160:161], v115 offset:2048
  ds_read_b64 v[168:169], v116 offset:2048
  ds_read_b64_tr_b16 v[162:163], v115 offset:2560
  ds_read_b64 v[170:171], v116 offset:2560
  s_waitcnt lgkmcnt(4)
  v_mfma_f32_32x32x16_bf16 v[140:155], v[156:159], v[164:167], v[140:155]
  s_add_u32 m0, s7, 32768
  s_nop 0
  buffer_load_dwordx4 v114, s[44:47], s8 offen sc1 lds
  ds_read_b64_tr_b16 v[156:157], v115 offset:4096
  ds_read_b64 v[164:165], v116 offset:4096
  ds_read_b64_tr_b16 v[158:159], v115 offset:4608
  ds_read_b64 v[166:167], v116 offset:4608
  s_waitcnt lgkmcnt(4)
  v_mfma_f32_32x32x16_bf16 v[140:155], v[160:163], v[168:171], v[140:155]
  s_add_u32 m0, s7, 33792
  s_add_u32 s8, s8, s4
  buffer_load_dwordx4 v114, s[44:47], s8 offen sc1 lds
  v_and_b32 v43, 1, v38
  v_lshlrev_b32 v43, 5, v43
  v_and_b32 v44, 3, v37
  v_lshl_add_u32 v43, v44, 3, v43
  s_lshl_b32 s70, s68, 6
  s_add_u32 s70, s70, 98304
  v_add3_u32 v179, v42, v43, s70
  ds_read_b64_tr_b16 v[160:161], v115 offset:6144
  ds_read_b64 v[168:169], v116 offset:6144
  ds_read_b64_tr_b16 v[162:163], v115 offset:6656
  ds_read_b64 v[170:171], v116 offset:6656
  s_waitcnt lgkmcnt(4)
  v_mfma_f32_32x32x16_bf16 v[140:155], v[156:159], v[164:167], v[140:155]
  s_add_u32 m0, s7, 34816
  s_add_u32 s8, s8, s4
  buffer_load_dwordx4 v114, s[44:47], s8 offen sc1 lds
  v_and_b32 v42, 31, v36
  s_lshl_b32 s70, s68, 5
  v_add_u32 v42, s70, v42
  s_lshl_b32 s70, s69, 2
  s_lshl_b32 s71, s67, 1
  s_add_u32 s70, s70, s71
  v_and_b32 v43, 7, v42
  v_lshlrev_b32 v42, 7, v42
  v_lshrrev_b32 v44, 5, v36
  v_lshl_add_u32 v42, v44, 3, v42
  v_add_u32 v42, 106496, v42
  v_xor_b32 v44, s70, v43
  v_lshl_add_u32 v180, v44, 4, v42
  s_add_u32 s70, s70, 1
  v_xor_b32 v44, s70, v43
  v_lshl_add_u32 v181, v44, 4, v42
  v_add_u32 v115, 65536, v115
  v_add_u32 v116, 65536, v116
  ds_read_b64_tr_b16 v[156:157], v115 offset:0
  ds_read_b64 v[164:165], v116 offset:0
  ds_read_b64_tr_b16 v[158:159], v115 offset:512
  ds_read_b64 v[166:167], v116 offset:512
  s_waitcnt lgkmcnt(4)
  v_mfma_f32_32x32x16_bf16 v[140:155], v[160:163], v[168:171], v[140:155]
  s_add_u32 m0, s7, 35840
  s_add_u32 s8, s8, s4
  buffer_load_dwordx4 v114, s[44:47], s8 offen sc1 lds
  s_waitcnt vmcnt(5)
  s_barrier
  s_mul_i32 s8, s9, s5
  s_add_u32 s9, s9, 1
  s_add_u32 s8, s8, s6
  s_cmp_eq_u32 s9, 11
  s_cselect_b32 s9, 0, s9
  ds_read_b64_tr_b16 v[160:161], v115 offset:2048
  ds_read_b64 v[168:169], v116 offset:2048
  ds_read_b64_tr_b16 v[162:163], v115 offset:2560
  ds_read_b64 v[170:171], v116 offset:2560
  s_waitcnt lgkmcnt(4)
  v_mfma_f32_32x32x16_bf16 v[140:155], v[156:159], v[164:167], v[140:155]
  s_add_u32 m0, s7, 65536
  s_nop 0
  buffer_load_dwordx4 v114, s[44:47], s8 offen sc1 lds
  ds_read_b64_tr_b16 v[156:157], v115 offset:4096
  ds_read_b64 v[164:165], v116 offset:4096
  ds_read_b64_tr_b16 v[158:159], v115 offset:4608
  ds_read_b64 v[166:167], v116 offset:4608
  s_waitcnt lgkmcnt(4)
  v_mfma_f32_32x32x16_bf16 v[140:155], v[160:163], v[168:171], v[140:155]
  s_add_u32 m0, s7, 66560
  s_add_u32 s8, s8, s4
  buffer_load_dwordx4 v114, s[44:47], s8 offen sc1 lds
  v_xor_b32 v43, v39, v40
  v_and_b32 v43, 7, v43
  v_lshlrev_b32 v43, 4, v43
  v_lshl_add_u32 v182, v39, 7, v43
  v_add_u32 v182, 106496, v182
  ds_read_b64_tr_b16 v[160:161], v115 offset:6144
  ds_read_b64 v[168:169], v116 offset:6144
  ds_read_b64_tr_b16 v[162:163], v115 offset:6656
  ds_read_b64 v[170:171], v116 offset:6656
  s_waitcnt lgkmcnt(4)
  v_mfma_f32_32x32x16_bf16 v[140:155], v[156:159], v[164:167], v[140:155]
  s_add_u32 m0, s7, 67584
  s_add_u32 s8, s8, s4
  buffer_load_dwordx4 v114, s[44:47], s8 offen sc1 lds
  v_add_u32 v115, 4294836224, v115
  v_add_u32 v116, 4294836224, v116
  ds_read_b64_tr_b16 v[156:157], v115 offset:0
  ds_read_b64 v[164:165], v116 offset:0
  ds_read_b64_tr_b16 v[158:159], v115 offset:512
  ds_read_b64 v[166:167], v116 offset:512
  s_waitcnt lgkmcnt(4)
  v_mfma_f32_32x32x16_bf16 v[140:155], v[160:163], v[168:171], v[140:155]
  s_add_u32 m0, s7, 68608
  s_add_u32 s8, s8, s4
  buffer_load_dwordx4 v114, s[44:47], s8 offen sc1 lds
  s_waitcnt vmcnt(4)
  s_barrier
  s_mul_i32 s8, s9, s5
  s_add_u32 s9, s9, 1
  s_add_u32 s8, s8, s6
  s_cmp_eq_u32 s9, 11
  s_cselect_b32 s9, 0, s9
  ds_read_b64_tr_b16 v[160:161], v115 offset:2048
  ds_read_b64 v[168:169], v116 offset:2048
  ds_read_b64_tr_b16 v[162:163], v115 offset:2560
  ds_read_b64 v[170:171], v116 offset:2560
  s_waitcnt lgkmcnt(4)
  v_mfma_f32_32x32x16_bf16 v[140:155], v[156:159], v[164:167], v[140:155]
  s_add_u32 m0, s7, 131072
  s_nop 0
  buffer_load_dwordx4 v114, s[44:47], s8 offen sc1 lds
  ds_read_b64_tr_b16 v[156:157], v115 offset:4096
  ds_read_b64 v[164:165], v116 offset:4096
  ds_read_b64_tr_b16 v[158:159], v115 offset:4608
  ds_read_b64 v[166:167], v116 offset:4608
  s_waitcnt lgkmcnt(4)
  v_mfma_f32_32x32x16_bf16 v[140:155], v[160:163], v[168:171], v[140:155]
  s_add_u32 m0, s7, 132096
  s_add_u32 s8, s8, s4
  buffer_load_dwordx4 v114, s[44:47], s8 offen sc1 lds
  ds_read_b64_tr_b16 v[160:161], v115 offset:6144
  ds_read_b64 v[168:169], v116 offset:6144
  ds_read_b64_tr_b16 v[162:163], v115 offset:6656
  ds_read_b64 v[170:171], v116 offset:6656
  s_waitcnt lgkmcnt(4)
  v_mfma_f32_32x32x16_bf16 v[140:155], v[156:159], v[164:167], v[140:155]
  s_add_u32 m0, s7, 133120
  s_add_u32 s8, s8, s4
  buffer_load_dwordx4 v114, s[44:47], s8 offen sc1 lds
  v_add_u32 v115, 32768, v115
  v_add_u32 v116, 32768, v116
  ds_read_b64_tr_b16 v[156:157], v115 offset:0
  ds_read_b64 v[164:165], v116 offset:0
  ds_read_b64_tr_b16 v[158:159], v115 offset:512
  ds_read_b64 v[166:167], v116 offset:512
  s_waitcnt lgkmcnt(4)
  v_mfma_f32_32x32x16_bf16 v[140:155], v[160:163], v[168:171], v[140:155]
  s_add_u32 m0, s7, 134144
  s_add_u32 s8, s8, s4
  buffer_load_dwordx4 v114, s[44:47], s8 offen sc1 lds
  s_waitcnt vmcnt(4)
  s_barrier
  s_mul_i32 s8, s9, s5
  s_add_u32 s9, s9, 1
  s_add_u32 s8, s8, s6
  s_cmp_eq_u32 s9, 11
  s_cselect_b32 s9, 0, s9
  ds_read_b64_tr_b16 v[160:161], v115 offset:2048
  ds_read_b64 v[168:169], v116 offset:2048
  ds_read_b64_tr_b16 v[162:163], v115 offset:2560
  ds_read_b64 v[170:171], v116 offset:2560
  s_waitcnt lgkmcnt(4)
  v_mfma_f32_32x32x16_bf16 v[140:155], v[156:159], v[164:167], v[140:155]
  s_add_u32 m0, s7, 0
  s_nop 0
  buffer_load_dwordx4 v114, s[44:47], s8 offen sc1 lds
  ds_read_b64_tr_b16 v[156:157], v115 offset:4096
  ds_read_b64 v[164:165], v116 offset:4096
  ds_read_b64_tr_b16 v[158:159], v115 offset:4608
  ds_read_b64 v[166:167], v116 offset:4608
  s_waitcnt lgkmcnt(4)
  v_mfma_f32_32x32x16_bf16 v[140:155], v[160:163], v[168:171], v[140:155]
  s_add_u32 m0, s7, 1024
  s_add_u32 s8, s8, s4
  buffer_load_dwordx4 v114, s[44:47], s8 offen sc1 lds
  ds_read_b64_tr_b16 v[160:161], v115 offset:6144
  ds_read_b64 v[168:169], v116 offset:6144
  ds_read_b64_tr_b16 v[162:163], v115 offset:6656
  ds_read_b64 v[170:171], v116 offset:6656
  s_waitcnt lgkmcnt(4)
  v_mfma_f32_32x32x16_bf16 v[140:155], v[156:159], v[164:167], v[140:155]
  s_add_u32 m0, s7, 2048
  s_add_u32 s8, s8, s4
  buffer_load_dwordx4 v114, s[44:47], s8 offen sc1 lds
  v_add_u32 v115, 32768, v115
  v_add_u32 v116, 32768, v116
  ds_read_b64_tr_b16 v[156:157], v115 offset:0
  ds_read_b64 v[164:165], v116 offset:0
  ds_read_b64_tr_b16 v[158:159], v115 offset:512
  ds_read_b64 v[166:167], v116 offset:512
  s_waitcnt lgkmcnt(4)
  v_mfma_f32_32x32x16_bf16 v[140:155], v[160:163], v[168:171], v[140:155]
  s_add_u32 m0, s7, 3072
  s_add_u32 s8, s8, s4
  buffer_load_dwordx4 v114, s[44:47], s8 offen sc1 lds
  s_waitcnt vmcnt(4)
  s_barrier
  s_mul_i32 s8, s9, s5
  s_add_u32 s9, s9, 1
  s_add_u32 s8, s8, s6
  s_cmp_eq_u32 s9, 11
  s_cselect_b32 s9, 0, s9
  ds_read_b64_tr_b16 v[160:161], v115 offset:2048
  ds_read_b64 v[168:169], v116 offset:2048
  ds_read_b64_tr_b16 v[162:163], v115 offset:2560
  ds_read_b64 v[170:171], v116 offset:2560
  s_waitcnt lgkmcnt(4)
  v_mfma_f32_32x32x16_bf16 v[140:155], v[156:159], v[164:167], v[140:155]
  s_add_u32 m0, s7, 32768
  s_nop 0
  buffer_load_dwordx4 v114, s[44:47], s8 offen sc1 lds
  ds_read_b64_tr_b16 v[156:157], v115 offset:4096
  ds_read_b64 v[164:165], v116 offset:4096
  ds_read_b64_tr_b16 v[158:159], v115 offset:4608
  ds_read_b64 v[166:167], v116 offset:4608
  s_waitcnt lgkmcnt(4)
  v_mfma_f32_32x32x16_bf16 v[140:155], v[160:163], v[168:171], v[140:155]
  s_add_u32 m0, s7, 33792
  s_add_u32 s8, s8, s4
  buffer_load_dwordx4 v114, s[44:47], s8 offen sc1 lds
  ds_read_b64_tr_b16 v[160:161], v115 offset:6144
  ds_read_b64 v[168:169], v116 offset:6144
  ds_read_b64_tr_b16 v[162:163], v115 offset:6656
  ds_read_b64 v[170:171], v116 offset:6656
  s_waitcnt lgkmcnt(4)
  v_mfma_f32_32x32x16_bf16 v[140:155], v[156:159], v[164:167], v[140:155]
  s_add_u32 m0, s7, 34816
  s_add_u32 s8, s8, s4
  buffer_load_dwordx4 v114, s[44:47], s8 offen sc1 lds
  v_add_u32 v115, 65536, v115
  v_add_u32 v116, 65536, v116
  ds_read_b64_tr_b16 v[156:157], v115 offset:0
  ds_read_b64 v[164:165], v116 offset:0
  ds_read_b64_tr_b16 v[158:159], v115 offset:512
  ds_read_b64 v[166:167], v116 offset:512
  s_waitcnt lgkmcnt(4)
  v_mfma_f32_32x32x16_bf16 v[140:155], v[160:163], v[168:171], v[140:155]
  s_add_u32 m0, s7, 35840
  s_add_u32 s8, s8, s4
  buffer_load_dwordx4 v114, s[44:47], s8 offen sc1 lds
  buffer_load_dwordx2 v[58:59], v60, s[52:55], 0 offen sc1
  s_waitcnt vmcnt(5)
  s_barrier
  s_mul_i32 s8, s9, s5
  s_add_u32 s9, s9, 1
  s_add_u32 s8, s8, s6
  s_cmp_eq_u32 s9, 11
  s_cselect_b32 s9, 0, s9
  ds_read_b64_tr_b16 v[160:161], v115 offset:2048
  ds_read_b64 v[168:169], v116 offset:2048
  ds_read_b64_tr_b16 v[162:163], v115 offset:2560
  ds_read_b64 v[170:171], v116 offset:2560
  s_waitcnt lgkmcnt(4)
  v_mfma_f32_32x32x16_bf16 v[140:155], v[156:159], v[164:167], v[140:155]
  s_add_u32 m0, s7, 65536
  s_nop 0
  buffer_load_dwordx4 v114, s[44:47], s8 offen sc1 lds
  ds_read_b64_tr_b16 v[156:157], v115 offset:4096
  ds_read_b64 v[164:165], v116 offset:4096
  ds_read_b64_tr_b16 v[158:159], v115 offset:4608
  ds_read_b64 v[166:167], v116 offset:4608
  s_waitcnt lgkmcnt(4)
  v_mfma_f32_32x32x16_bf16 v[140:155], v[160:163], v[168:171], v[140:155]
  s_add_u32 m0, s7, 66560
  s_add_u32 s8, s8, s4
  buffer_load_dwordx4 v114, s[44:47], s8 offen sc1 lds
  ds_read_b64_tr_b16 v[160:161], v115 offset:6144
  ds_read_b64 v[168:169], v116 offset:6144
  ds_read_b64_tr_b16 v[162:163], v115 offset:6656
  ds_read_b64 v[170:171], v116 offset:6656
  s_waitcnt lgkmcnt(4)
  v_mfma_f32_32x32x16_bf16 v[140:155], v[156:159], v[164:167], v[140:155]
  s_add_u32 m0, s7, 67584
  s_add_u32 s8, s8, s4
  buffer_load_dwordx4 v114, s[44:47], s8 offen sc1 lds
  v_add_u32 v115, 4294836224, v115
  v_add_u32 v116, 4294836224, v116
  ds_read_b64_tr_b16 v[156:157], v115 offset:0
  ds_read_b64 v[164:165], v116 offset:0
  ds_read_b64_tr_b16 v[158:159], v115 offset:512
  ds_read_b64 v[166:167], v116 offset:512
  s_waitcnt lgkmcnt(4)
  v_mfma_f32_32x32x16_bf16 v[140:155], v[160:163], v[168:171], v[140:155]
  s_add_u32 m0, s7, 68608
  s_add_u32 s8, s8, s4
  buffer_load_dwordx4 v114, s[44:47], s8 offen sc1 lds
  buffer_load_dwordx4 v[172:175], v54, s[36:39], s13 offen
  s_waitcnt vmcnt(6)
  s_barrier
  ds_read_b64_tr_b16 v[160:161], v115 offset:2048
  ds_read_b64 v[168:169], v116 offset:2048
  ds_read_b64_tr_b16 v[162:163], v115 offset:2560
  ds_read_b64 v[170:171], v116 offset:2560
  s_waitcnt lgkmcnt(4)
  v_mfma_f32_32x32x16_bf16 v[140:155], v[156:159], v[164:167], v[140:155]
  ds_read_b64_tr_b16 v[156:157], v115 offset:4096
  ds_read_b64 v[164:165], v116 offset:4096
  ds_read_b64_tr_b16 v[158:159], v115 offset:4608
  ds_read_b64 v[166:167], v116 offset:4608
  s_waitcnt lgkmcnt(4)
  v_mfma_f32_32x32x16_bf16 v[140:155], v[160:163], v[168:171], v[140:155]
  ds_read_b64_tr_b16 v[160:161], v115 offset:6144
  ds_read_b64 v[168:169], v116 offset:6144
  ds_read_b64_tr_b16 v[162:163], v115 offset:6656
  ds_read_b64 v[170:171], v116 offset:6656
  s_waitcnt lgkmcnt(4)
  v_mfma_f32_32x32x16_bf16 v[140:155], v[156:159], v[164:167], v[140:155]
  v_add_u32 v115, 32768, v115
  v_add_u32 v116, 32768, v116
  ds_read_b64_tr_b16 v[156:157], v115 offset:0
  ds_read_b64 v[164:165], v116 offset:0
  ds_read_b64_tr_b16 v[158:159], v115 offset:512
  ds_read_b64 v[166:167], v116 offset:512
  s_waitcnt lgkmcnt(4)
  v_mfma_f32_32x32x16_bf16 v[140:155], v[160:163], v[168:171], v[140:155]
  s_waitcnt vmcnt(1)
  s_cmp_lg_u32 s60, 0
  s_cbranch_scc1 F_s0_52
  s_waitcnt vmcnt(1)
  v_cmp_ne_u64 vcc, v[58:59], v[56:57]
  s_cbranch_vccnz F_slow_53
F_back_54:
F_s0_52:
  s_barrier
  ds_read_b64_tr_b16 v[160:161], v115 offset:2048
  ds_read_b64 v[168:169], v116 offset:2048
  ds_read_b64_tr_b16 v[162:163], v115 offset:2560
  ds_read_b64 v[170:171], v116 offset:2560
  s_waitcnt lgkmcnt(4)
  v_mfma_f32_32x32x16_bf16 v[140:155], v[156:159], v[164:167], v[140:155]
  s_lshl_b32 s70, s62, 18
  s_lshl_b32 s71, s61, 7
  s_add_u32 s70, s70, s71
  s_add_u32 s70, s70, 8388608
  s_add_u32 m0, s75, 98304
  s_nop 0
  buffer_load_dwordx4 v176, s[52:55], s70 offen sc1 lds
  ds_read_b64_tr_b16 v[156:157], v115 offset:4096
  ds_read_b64 v[164:165], v116 offset:4096
  ds_read_b64_tr_b16 v[158:159], v115 offset:4608
  ds_read_b64 v[166:167], v116 offset:4608
  s_waitcnt lgkmcnt(4)
  v_mfma_f32_32x32x16_bf16 v[140:155], v[160:163], v[168:171], v[140:155]
  ds_read_b64_tr_b16 v[160:161], v115 offset:6144
  ds_read_b64 v[168:169], v116 offset:6144
  ds_read_b64_tr_b16 v[162:163], v115 offset:6656
  ds_read_b64 v[170:171], v116 offset:6656
  s_waitcnt lgkmcnt(4)
  v_mfma_f32_32x32x16_bf16 v[140:155], v[156:159], v[164:167], v[140:155]
  v_add_u32 v115, 32768, v115
  v_add_u32 v116, 32768, v116
  ds_read_b64_tr_b16 v[156:157], v115 offset:0
  ds_read_b64 v[164:165], v116 offset:0
  ds_read_b64_tr_b16 v[158:159], v115 offset:512
  ds_read_b64 v[166:167], v116 offset:512
  s_waitcnt lgkmcnt(4)
  v_mfma_f32_32x32x16_bf16 v[140:155], v[160:163], v[168:171], v[140:155]
  ds_read_b64_tr_b16 v[160:161], v115 offset:2048
  ds_read_b64 v[168:169], v116 offset:2048
  ds_read_b64_tr_b16 v[162:163], v115 offset:2560
  ds_read_b64 v[170:171], v116 offset:2560
  s_waitcnt lgkmcnt(4)
  v_mfma_f32_32x32x16_bf16 v[140:155], v[156:159], v[164:167], v[140:155]
  ds_read_b64_tr_b16 v[156:157], v115 offset:4096
  ds_read_b64 v[164:165], v116 offset:4096
  ds_read_b64_tr_b16 v[158:159], v115 offset:4608
  ds_read_b64 v[166:167], v116 offset:4608
  s_waitcnt lgkmcnt(4)
  v_mfma_f32_32x32x16_bf16 v[140:155], v[160:163], v[168:171], v[140:155]
  ds_read_b64_tr_b16 v[160:161], v115 offset:6144
  ds_read_b64 v[168:169], v116 offset:6144
  ds_read_b64_tr_b16 v[162:163], v115 offset:6656
  ds_read_b64 v[170:171], v116 offset:6656
  s_waitcnt lgkmcnt(4)
  v_mfma_f32_32x32x16_bf16 v[140:155], v[156:159], v[164:167], v[140:155]
  s_waitcnt lgkmcnt(0)
  v_mfma_f32_32x32x16_bf16 v[140:155], v[160:163], v[168:171], v[140:155]
  s_mov_b32 s40, s26
  s_and_b32 s41, s27, 0xffff
  s_mov_b32 s42, 2097152
  s_mov_b32 s43, 0x00020000
  s_nop 7
  s_cmp_eq_u32 s67, 1
  s_cbranch_scc1 F_kg1_55
  ds_write_b128 v177, v[148:151]
  ds_write_b128 v177, v[152:155] offset:1024
  v_pk_mul_f32 v[184:185], v[140:141], 1.0 op_sel_hi:[1,0]
  v_pk_mul_f32 v[186:187], v[142:143], 1.0 op_sel_hi:[1,0]
  v_pk_mul_f32 v[188:189], v[144:145], 1.0 op_sel_hi:[1,0]
  v_pk_mul_f32 v[190:191], v[146:147], 1.0 op_sel_hi:[1,0]
  s_branch F_kgj_56
F_kg1_55:
  ds_write_b128 v177, v[140:143]
  ds_write_b128 v177, v[144:147] offset:1024
  v_pk_mul_f32 v[184:185], v[148:149], 1.0 op_sel_hi:[1,0]
  v_pk_mul_f32 v[186:187], v[150:151], 1.0 op_sel_hi:[1,0]
  v_pk_mul_f32 v[188:189], v[152:153], 1.0 op_sel_hi:[1,0]
  v_pk_mul_f32 v[190:191], v[154:155], 1.0 op_sel_hi:[1,0]
F_kgj_56:
  s_waitcnt vmcnt(0)
  s_waitcnt lgkmcnt(0)
  s_barrier
  ds_read_b128 v[192:195], v178
  ds_read_b128 v[196:199], v178 offset:1024
  ds_read_b64_tr_b16 v[200:201], v179
  ds_read_b64_tr_b16 v[202:203], v179 offset:1024
  v_lshlrev_b32 v20, 16, v172
  v_and_b32 v21, 0xffff0000, v172
  v_lshlrev_b32 v22, 16, v173
  v_and_b32 v23, 0xffff0000, v173
  v_lshlrev_b32 v24, 16, v174
  v_and_b32 v25, 0xffff0000, v174
  v_lshlrev_b32 v26, 16, v175
  v_and_b32 v27, 0xffff0000, v175
  v_mov_b32 v42, 0xbfb8aa3b
  s_waitcnt lgkmcnt(2)
  v_pk_add_f32 v[184:185], v[184:185], v[192:193]
  v_pk_add_f32 v[186:187], v[186:187], v[194:195]
  v_pk_add_f32 v[188:189], v[188:189], v[196:197]
  v_pk_add_f32 v[190:191], v[190:191], v[198:199]
  v_pk_mul_f32 v[4:5], v[184:185], v[42:43] op_sel_hi:[1,0]
  v_pk_mul_f32 v[6:7], v[186:187], v[42:43] op_sel_hi:[1,0]
  v_pk_mul_f32 v[8:9], v[188:189], v[42:43] op_sel_hi:[1,0]
  v_pk_mul_f32 v[10:11], v[190:191], v[42:43] op_sel_hi:[1,0]
  v_exp_f32 v4, v4
  v_exp_f32 v5, v5
  v_exp_f32 v6, v6
  v_exp_f32 v7, v7
  v_exp_f32 v8, v8
  v_exp_f32 v9, v9
  v_exp_f32 v10, v10
  v_exp_f32 v11, v11
  s_waitcnt lgkmcnt(0)
  v_lshlrev_b32 v12, 16, v200
  v_and_b32 v13, 0xffff0000, v200
  v_lshlrev_b32 v14, 16, v201
  v_and_b32 v15, 0xffff0000, v201
  v_lshlrev_b32 v16, 16, v202
  v_and_b32 v17, 0xffff0000, v202
  v_lshlrev_b32 v18, 16, v203
  v_and_b32 v19, 0xffff0000, v203
  v_pk_add_f32 v[4:5], v[4:5], 1.0 op_sel_hi:[1,0]
  v_pk_add_f32 v[6:7], v[6:7], 1.0 op_sel_hi:[1,0]
  v_pk_add_f32 v[8:9], v[8:9], 1.0 op_sel_hi:[1,0]
  v_pk_add_f32 v[10:11], v[10:11], 1.0 op_sel_hi:[1,0]
  v_pk_mul_f32 v[184:185], v[184:185], v[12:13]
  v_pk_mul_f32 v[186:187], v[186:187], v[14:15]
  v_pk_mul_f32 v[188:189], v[188:189], v[16:17]
  v_pk_mul_f32 v[190:191], v[190:191], v[18:19]
  v_rcp_f32 v4, v4
  v_rcp_f32 v5, v5
  v_rcp_f32 v6, v6
  v_rcp_f32 v7, v7
  v_rcp_f32 v8, v8
  v_rcp_f32 v9, v9
  v_rcp_f32 v10, v10
  v_rcp_f32 v11, v11
  s_nop 0
  v_pk_mul_f32 v[184:185], v[184:185], v[4:5]
  v_pk_mul_f32 v[186:187], v[186:187], v[6:7]
  v_pk_mul_f32 v[188:189], v[188:189], v[8:9]
  v_pk_mul_f32 v[190:191], v[190:191], v[10:11]
  v_cvt_pk_bf16_f32 v28, v184, v185
  v_cvt_pk_bf16_f32 v29, v186, v187
  v_cvt_pk_bf16_f32 v30, v188, v189
  v_cvt_pk_bf16_f32 v31, v190, v191
  ds_write_b64 v180, v[28:29]
  ds_write_b64 v181, v[30:31]
  s_waitcnt lgkmcnt(0)
  s_barrier
  ds_read_b128 v[200:203], v182
  s_waitcnt lgkmcnt(0)
  v_lshlrev_b32 v12, 16, v200
  v_and_b32 v13, 0xffff0000, v200
  v_lshlrev_b32 v14, 16, v201
  v_and_b32 v15, 0xffff0000, v201
  v_lshlrev_b32 v16, 16, v202
  v_and_b32 v17, 0xffff0000, v202
  v_lshlrev_b32 v18, 16, v203
  v_and_b32 v19, 0xffff0000, v203
  v_pk_add_f32 v[20:21], v[20:21], v[12:13]
  v_pk_add_f32 v[22:23], v[22:23], v[14:15]
  v_pk_add_f32 v[24:25], v[24:25], v[16:17]
  v_pk_add_f32 v[26:27], v[26:27], v[18:19]
  v_cvt_pk_bf16_f32 v200, v20, v21
  v_cvt_pk_bf16_f32 v201, v22, v23
  v_cvt_pk_bf16_f32 v202, v24, v25
  v_cvt_pk_bf16_f32 v203, v26, v27
  buffer_store_dwordx4 v[200:203], v54, s[40:43], s13 offen sc1
F_end_1:
  s_endpgm
F_slow_9:
  s_mov_b32 s72, 0
F_slow_9_l:
  s_sleep 1
  buffer_load_dwordx2 v[56:57], v60, s[56:59], 0 offen sc1
  s_waitcnt vmcnt(0)
  v_cmp_eq_u32 vcc, 0, v56
  s_add_u32 s72, s72, 1
  s_cbranch_vccz F_back_10
  s_cmp_lt_u32 s72, 262144
  s_cbranch_scc1 F_slow_9_l
  s_branch F_back_10
F_slow_13:
  s_mov_b32 s72, 0
F_slow_13_l:
  s_sleep 1
  buffer_load_dwordx4 v[244:247], v110, s[52:55], 0 offen sc1
  s_waitcnt vmcnt(0)
  v_cmp_ne_u64 vcc, v[246:247], v[56:57]
  s_add_u32 s72, s72, 1
  s_cbranch_vccz F_back_14
  s_cmp_lt_u32 s72, 262144
  s_cbranch_scc1 F_slow_13_l
  s_branch F_back_14
F_slow_15:
  s_mov_b32 s72, 0
F_slow_15_l:
  s_sleep 1
  buffer_load_dwordx4 v[244:247], v110, s[52:55], 0 offen sc1
  s_waitcnt vmcnt(0)
  v_cmp_ne_u64 vcc, v[246:247], v[56:57]
  s_add_u32 s72, s72, 1
  s_cbranch_vccz F_back_16
  s_cmp_lt_u32 s72, 262144
  s_cbranch_scc1 F_slow_15_l
  s_branch F_back_16
F_uslow_32:
  s_mov_b32 s72, 0
F_uslow_32_l:
  s_sleep 1
  buffer_load_dwordx4 v[132:135], v111, s[52:55], 0 offen offset:0 sc1
  buffer_load_dwordx4 v[136:139], v111, s[52:55], 0 offen offset:1024 sc1
  s_waitcnt vmcnt(0)
  v_cmp_ne_u64 vcc, v[134:135], v[56:57]
  v_cmp_ne_u64 s[18:19], v[138:139], v[56:57]
  s_nop 1
  s_or_b64 vcc, vcc, s[18:19]
  s_add_u32 s72, s72, 1
  s_cbranch_vccz F_uback_33
  s_cmp_lt_u32 s72, 262144
  s_cbranch_scc1 F_uslow_32_l
  s_branch F_uback_33
F_slow_45:
  s_mov_b32 s72, 0
F_slow_45_l:
  s_sleep 1
  buffer_load_dwordx2 v[58:59], v60, s[52:55], 0 offen sc1
  s_waitcnt vmcnt(0)
  v_cmp_ne_u64 vcc, v[58:59], v[56:57]
  s_add_u32 s72, s72, 1
  s_cbranch_vccz F_back_46
  s_cmp_lt_u32 s72, 262144
  s_cbranch_scc1 F_slow_45_l
  s_branch F_back_46
F_slow_50:
  s_mov_b32 s72, 0
F_slow_50_l:
  s_sleep 1
  buffer_load_dwordx2 v[58:59], v60, s[52:55], 0 offen sc1
  s_waitcnt vmcnt(0)
  v_cmp_ne_u64 vcc, v[58:59], v[56:57]
  s_add_u32 s72, s72, 1
  s_cbranch_vccz F_back_51
  s_cmp_lt_u32 s72, 262144
  s_cbranch_scc1 F_slow_50_l
  s_branch F_back_51
F_slow_53:
  s_mov_b32 s72, 0
F_slow_53_l:
  s_sleep 1
  buffer_load_dwordx2 v[58:59], v60, s[52:55], 0 offen sc1
  s_waitcnt vmcnt(0)
  v_cmp_ne_u64 vcc, v[58:59], v[56:57]
  s_add_u32 s72, s72, 1
  s_cbranch_vccz F_back_54
  s_cmp_lt_u32 s72, 262144
  s_cbranch_scc1 F_slow_53_l
  s_branch F_back_54
.section .rodata,"a"
.p2align 6
.amdhsa_kernel recurrent_scan__ssm_conv_s4d__dense_activation_mish__prompt_kernel
    .amdhsa_next_free_vgpr 256
    .amdhsa_next_free_sgpr 102
    .amdhsa_accum_offset 256
    .amdhsa_group_segment_fixed_size 0
    .amdhsa_kernarg_size 112
    .amdhsa_user_sgpr_count 2
    .amdhsa_user_sgpr_kernarg_segment_ptr 1
    .amdhsa_system_sgpr_workgroup_id_x 1
    .amdhsa_float_denorm_mode_32 3
    .amdhsa_float_denorm_mode_16_64 3
.end_amdhsa_kernel
```
